```python
import torch

def _softmax(x, axis=-1):
    return torch.softmax(x, dim=axis)
def _gelu(x):
    return torch.nn.functional.gelu(x, approximate="tanh")
def _silu(x):
    return torch.nn.functional.silu(x)
def _sigmoid(x):
    return torch.sigmoid(x)
def _layernorm(x, axis=-1, eps=1e-5):
    m = x.mean(dim=axis, keepdim=True)
    v = x.var(dim=axis, keepdim=True, unbiased=False)
    return (x - m) / torch.sqrt(v + eps)
def _scatter_add(tgt, idx, src, axis=0):
    return tgt.clone().index_add_(axis, idx, src)
def _segment_sum(src, seg, n):
    out = torch.zeros((n,) + src.shape[1:], dtype=src.dtype)
    return out.index_add_(0, seg, src)
def _pad(x, pw):
    flat = tuple(v for pair in reversed(pw) for v in pair)
    return torch.nn.functional.pad(x, flat)

kernel_name = 'standalone__paged_block_table_kv_pagedattention__sampling'

def setup_inputs():

    _w = (lambda a: (lambda t: t.to(torch.bfloat16) if t.is_floating_point() else t)(torch.as_tensor(a)))
    B, Hq, Hkv, Sq, Skv, D = 8, 32, 32, 16, 2048, 128
    bs = 16
    nbps = max(1, Skv // bs)
    num_phys = B * nbps + 4
    bt = torch.randperm(num_phys)[: B * nbps].reshape(B, nbps).to(torch.int64)
    cl = (nbps * bs - (torch.arange(1, B + 1, dtype=torch.int64) * 2654435761) % max(1, nbps * bs // 2)).to(torch.int64)
    return {
        "q": _w((lambda *s: torch.randn(*s, dtype=torch.bfloat16) * 0.8)(B, Hq, Sq, D)),
        "k_cache": _w((lambda *s: torch.randn(*s, dtype=torch.bfloat16) * 0.8)(num_phys, bs, Hkv, D)),
        "v_cache": _w((lambda *s: torch.randn(*s, dtype=torch.bfloat16) * 0.05)(num_phys, bs, Hkv, D)),
        "block_table": _w(bt),
        "context_lens": _w(cl),
    }

def reference(q, k_cache, v_cache, block_table, context_lens):
    B, Hq, Sq, D = q.shape
    bs = k_cache.shape[1]
    Hkv = k_cache.shape[2]
    nbps = block_table.shape[1]
    Skv = nbps * bs
    bt = block_table.reshape(-1)
    k = (lambda x, *d: x.permute(*d))(k_cache[bt].reshape(B, Skv, Hkv, D), 0, 2, 1, 3)
    v = (lambda x, *d: x.permute(*d))(v_cache[bt].reshape(B, Skv, Hkv, D), 0, 2, 1, 3)
    g = Hq // Hkv
    qg = q.reshape(B, Hkv, g, Sq, D)
    scores = torch.einsum("bhgqd,bhkd->bhgqk", qg, k) * (D ** -0.5)
    pos = torch.arange(Skv)
    msk = pos[None, :] < context_lens[:, None]
    scores = torch.where(msk[:, None, None, None, :], scores, -1e9)
    p = _softmax(scores, axis=-1)
    out = torch.einsum("bhgqk,bhkd->bhgqd", p, v)
    return out.reshape(B, Hq, Sq, D)
```

```asm
; @launch grid=(256,1,1) block=(192,1,1) lds=143872
.amdgcn_target "amdgcn-amd-amdhsa--gfx950"
.text
.globl standalone__paged_block_table_kv_pagedattention__sampling_kernel
.p2align 8
.type standalone__paged_block_table_kv_pagedattention__sampling_kernel,@function
standalone__paged_block_table_kv_pagedattention__sampling_kernel:
    s_load_dwordx16 s[48:63], s[0:1], 0
    s_lshr_b32 s35, s2, 5
    v_readfirstlane_b32 s34, v0
    s_cmp_ge_u32 s35, 8
    s_cbranch_scc1 L_end
    s_lshl_b32 s45, s35, 9
    s_cmp_ge_u32 s34, 64
    s_cbranch_scc1 L_consumer
    s_cmp_ge_u32 s35, 6
    s_addc_u32 s36, s2, s35
    s_waitcnt lgkmcnt(0)
    s_load_dwordx8 s[80:87], s[54:55], s45
    v_lshrrev_b32 v2, 4, v0
    v_and_b32 v3, 15, v0
    v_lshlrev_b32 v14, 1, v2
    v_xor_b32 v14, v14, v3
    v_lshlrev_b32 v15, 13, v2
    v_lshl_add_u32 v4, v14, 4, v15
    v_xor_b32 v14, 0x80, v4
    v_add_u32 v5, 31744, v14
    v_add_u32 v6, 63488, v4
    v_add_u32 v7, 95232, v14
    s_and_b32 s36, s36, 31
    s_lshl_b32 s46, s36, 8
    s_mov_b32 m0, 0
    s_mov_b32 s8, s50
    s_and_b32 s9, s51, 0xffff
    s_mov_b32 s10, 134742016
    s_mov_b32 s11, 0x20000
    s_waitcnt lgkmcnt(0)
    s_lshl_b32 s80, s80, 17
    s_or_b32 s80, s80, s46
    buffer_load_dwordx4 v4, s[8:11], s80 offen offset:0 nt lds
    buffer_load_dwordx4 v5, s[8:11], s80 offen offset:1024 nt lds
    buffer_load_dwordx4 v6, s[8:11], s80 offen offset:2048 nt lds
    buffer_load_dwordx4 v7, s[8:11], s80 offen offset:3072 nt lds
    s_mov_b32 m0, 4096
    s_lshl_b32 s81, s81, 17
    s_or_b32 s81, s81, s46
    buffer_load_dwordx4 v4, s[8:11], s81 offen offset:0 nt lds
    buffer_load_dwordx4 v5, s[8:11], s81 offen offset:1024 nt lds
    buffer_load_dwordx4 v6, s[8:11], s81 offen offset:2048 nt lds
    buffer_load_dwordx4 v7, s[8:11], s81 offen offset:3072 nt lds
    s_mov_b32 m0, 16384
    s_lshl_b32 s82, s82, 17
    s_or_b32 s82, s82, s46
    buffer_load_dwordx4 v4, s[8:11], s82 offen offset:0 nt lds
    buffer_load_dwordx4 v5, s[8:11], s82 offen offset:1024 nt lds
    buffer_load_dwordx4 v6, s[8:11], s82 offen offset:2048 nt lds
    buffer_load_dwordx4 v7, s[8:11], s82 offen offset:3072 nt lds
    s_mov_b32 m0, 20480
    s_lshl_b32 s83, s83, 17
    s_or_b32 s83, s83, s46
    buffer_load_dwordx4 v4, s[8:11], s83 offen offset:0 nt lds
    buffer_load_dwordx4 v5, s[8:11], s83 offen offset:1024 nt lds
    buffer_load_dwordx4 v6, s[8:11], s83 offen offset:2048 nt lds
    buffer_load_dwordx4 v7, s[8:11], s83 offen offset:3072 nt lds
    s_mov_b32 s12, s52
    s_and_b32 s13, s53, 0xffff
    s_mov_b32 s14, 134742016
    s_mov_b32 s15, 0x20000
    s_mov_b32 m0, 8192
    s_nop 0
    buffer_load_dwordx4 v4, s[12:15], s80 offen offset:0 nt lds
    buffer_load_dwordx4 v5, s[12:15], s80 offen offset:1024 nt lds
    v_lshlrev_b32 v19, 2, v0
    v_add_u32 v19, 131072, v19
    v_mov_b32 v22, 0
    ds_write_b32 v19, v22 offset:0
    ds_write_b32 v19, v22 offset:256
    ds_write_b32 v19, v22 offset:512
    ds_write_b32 v19, v22 offset:768
    ds_write_b32 v19, v22 offset:1024
    ds_write_b32 v19, v22 offset:1280
    ds_write_b32 v19, v22 offset:1536
    ds_write_b32 v19, v22 offset:1792
    ds_write_b32 v19, v22 offset:2048
    ds_write_b32 v19, v22 offset:2304
    v_add_u32 v20, 1280, v19
    v_lshlrev_b32 v14, 4, v0
    v_add_u32 v14, 133632, v14
    v_mov_b32 v15, 134912
    s_mov_b32 s43, 0x100000
    s_getpc_b64 s[64:65]
L_pc:
    s_add_u32 s64, s64, L_var-L_pc-2048
    s_addc_u32 s65, s65, 0
    s_waitcnt vmcnt(17)
    buffer_load_dwordx4 v6, s[12:15], s80 offen offset:2048 nt lds
    s_waitcnt vmcnt(17)
    buffer_load_dwordx4 v7, s[12:15], s80 offen offset:3072 nt lds
    s_mov_b32 m0, 12288
    s_waitcnt vmcnt(17)
    buffer_load_dwordx4 v4, s[12:15], s81 offen offset:0 nt lds
    s_waitcnt vmcnt(17)
    buffer_load_dwordx4 v5, s[12:15], s81 offen offset:1024 nt lds
    s_waitcnt vmcnt(17)
    buffer_load_dwordx4 v6, s[12:15], s81 offen offset:2048 nt lds
    s_waitcnt vmcnt(17)
    buffer_load_dwordx4 v7, s[12:15], s81 offen offset:3072 nt lds
    s_mov_b32 m0, 32768
    s_lshl_b32 s84, s84, 17
    s_or_b32 s84, s84, s46
    s_waitcnt vmcnt(17)
    buffer_load_dwordx4 v4, s[8:11], s84 offen offset:0 nt lds
    s_waitcnt vmcnt(17)
    buffer_load_dwordx4 v5, s[8:11], s84 offen offset:1024 nt lds
    s_waitcnt vmcnt(17)
    buffer_load_dwordx4 v6, s[8:11], s84 offen offset:2048 nt lds
    s_waitcnt vmcnt(17)
    buffer_load_dwordx4 v7, s[8:11], s84 offen offset:3072 nt lds
    s_mov_b32 m0, 36864
    s_lshl_b32 s85, s85, 17
    s_or_b32 s85, s85, s46
    s_waitcnt vmcnt(17)
    buffer_load_dwordx4 v4, s[8:11], s85 offen offset:0 nt lds
    s_waitcnt vmcnt(17)
    buffer_load_dwordx4 v5, s[8:11], s85 offen offset:1024 nt lds
    s_waitcnt vmcnt(17)
    buffer_load_dwordx4 v6, s[8:11], s85 offen offset:2048 nt lds
    s_waitcnt vmcnt(17)
    buffer_load_dwordx4 v7, s[8:11], s85 offen offset:3072 nt lds
    s_mov_b32 m0, 24576
    s_waitcnt vmcnt(17)
    buffer_load_dwordx4 v4, s[12:15], s82 offen offset:0 nt lds
    s_waitcnt vmcnt(17)
    buffer_load_dwordx4 v5, s[12:15], s82 offen offset:1024 nt lds
    s_waitcnt vmcnt(17)
    buffer_load_dwordx4 v6, s[12:15], s82 offen offset:2048 nt lds
    s_waitcnt vmcnt(17)
    buffer_load_dwordx4 v7, s[12:15], s82 offen offset:3072 nt lds
    s_mov_b32 m0, 28672
    s_waitcnt vmcnt(17)
    buffer_load_dwordx4 v4, s[12:15], s83 offen offset:0 nt lds
    s_waitcnt vmcnt(17)
    buffer_load_dwordx4 v5, s[12:15], s83 offen offset:1024 nt lds
    s_waitcnt vmcnt(17)
    buffer_load_dwordx4 v6, s[12:15], s83 offen offset:2048 nt lds
    s_waitcnt vmcnt(17)
    buffer_load_dwordx4 v7, s[12:15], s83 offen offset:3072 nt lds
    s_waitcnt lgkmcnt(0)
    s_barrier
    ds_read_b128 v[8:11], v14
    ds_read_b32 v16, v19 offset:3584
    ds_read_b128 v[24:27], v15
    ds_read_b32 v21, v20
    s_mov_b32 s37, 2
    s_mov_b32 s47, 40960
    s_mov_b32 s29, 8
    s_waitcnt lgkmcnt(0)
    v_readfirstlane_b32 s33, v24
    v_readfirstlane_b32 s66, v26
    v_readfirstlane_b32 s67, v27
    s_nop 0
    s_min_u32 s33, s33, 64
L_next:
    s_cmp_ge_u32 s37, s33
    s_cbranch_scc1 L_drain
    v_readlane_b32 s40, v8, s37
    v_readlane_b32 s41, v9, s37
    v_readlane_b32 s31, v10, s37
    v_readlane_b32 s32, v11, s37
    v_readlane_b32 s46, v16, s37
L_chk:
    s_waitcnt lgkmcnt(0)
    v_readfirstlane_b32 s44, v21
    v_readfirstlane_b32 s30, v25
    s_lshl1_add_u32 s38, s37, 1
    s_and_b32 m0, s46, 114688
    s_add_u32 s44, s44, 6
    s_cmp_gt_u32 s44, s37
    s_cbranch_scc0 L_slow
    v_add_u32 v20, -131072, v20
    v_and_b32 v20, 2047, v20
    v_add_u32 v20, 131328, v20
    s_mov_b32 s39, s47
    s_add_u32 s47, s47, 16384
    s_and_b32 s47, s47, 131071
    s_and_b32 s29, s29, 15
    s_add_u32 s29, s29, s30
    s_lshr_b32 s44, s29, 4
    s_max_u32 s44, s44, 8
    s_min_u32 s44, s44, 40
    s_bitcmp1_b64 s[66:67], s37
    s_cselect_b32 s45, 33, 0
    s_add_u32 s44, s44, s45
    s_add_u32 s37, s37, 1
    s_lshl_b32 s44, s44, 8
    s_add_u32 s68, s64, s44
    s_addc_u32 s69, s65, 0
    ds_read_b32 v21, v20
    ds_read_b32 v25, v15 offset:4
    s_setpc_b64 s[68:69]
L_slow:
    ds_read_b32 v21, v20
    s_sub_u32 s43, s43, 1
    s_cbranch_scc0 L_chk
    s_endpgm
L_drain:
    s_lshl1_add_u32 s38, s37, 1
    s_sub_i32 s44, s38, 4
    v_mov_b32 v22, s44
    s_waitcnt vmcnt(32)
    ds_write_b32 v19, v22
    s_sub_i32 s44, s38, 3
    v_mov_b32 v22, s44
    s_waitcnt vmcnt(24)
    ds_write_b32 v19, v22
    s_sub_i32 s44, s38, 2
    v_mov_b32 v22, s44
    s_waitcnt vmcnt(16)
    ds_write_b32 v19, v22
    s_sub_i32 s44, s38, 1
    v_mov_b32 v22, s44
    s_waitcnt vmcnt(8)
    ds_write_b32 v19, v22
    v_mov_b32 v22, s38
    s_waitcnt vmcnt(0)
    ds_write_b32 v19, v22
    s_barrier
    s_endpgm
.p2align 6
L_consumer:
    v_and_b32 v1, 63, v0
    s_lshr_b32 s34, s34, 6
    s_cmp_eq_u32 s34, 1
    s_cbranch_scc1 L_nowarm
    s_getpc_b64 s[70:71]
L_pc2:
    s_lshr_b32 s44, s2, 3
    s_lshl_b32 s44, s44, 10
    s_min_u32 s44, s44, L_code_end-standalone__paged_block_table_kv_pagedattention__sampling_kernel-1024
    s_sub_u32 s70, s70, L_pc2-standalone__paged_block_table_kv_pagedattention__sampling_kernel
    s_subb_u32 s71, s71, 0
    v_lshl_add_u32 v144, v1, 6, s44
    s_mov_b64 exec, 0xffff
    global_load_dword v172, v144, s[70:71]
    s_mov_b64 exec, -1
L_nowarm:
    s_mov_b32 s3, s2
    s_cmp_ge_u32 s35, 6
    s_addc_u32 s36, s2, s35
    s_and_b32 s36, s36, 31
    s_and_b32 s2, s2, 0xe0
    s_or_b32 s2, s2, s36
    s_mov_b32 s43, 0x100000
    v_lshrrev_b32 v2, 4, v1
    v_and_b32 v3, 15, v1
    s_sub_u32 s42, s34, 1
    v_lshrrev_b32 v64, 3, v1
    v_and_b32 v65, 7, v1
    v_lshlrev_b32 v144, 2, v64
    v_lshlrev_b32 v145, 2, v65
    v_lshlrev_b32 v146, 8, v3
    v_lshl_add_u32 v146, v2, 4, v146
    v_lshlrev_b32 v156, 4, v1
    s_lshl_b32 s45, s2, 12
    s_mov_b32 s28, 0x3e0293ee
    s_lshl_b32 s44, s42, 12
    s_add_u32 m0, s44, 135168
    s_waitcnt lgkmcnt(0)
    s_mov_b32 s76, s56
    s_and_b32 s77, s57, 0xffff
    s_mov_b32 s78, 32
    s_mov_b32 s79, 0x20000
    buffer_load_dword v66, v144, s[76:79], 0 offen
    buffer_load_dword v67, v145, s[76:79], 0 offen
    s_mov_b32 s24, s54
    s_and_b32 s25, s55, 0xffff
    s_mov_b32 s26, 4096
    s_mov_b32 s27, 0x20000
    buffer_load_dwordx4 v156, s[24:27], 0 offen offset:0 lds
    buffer_load_dwordx4 v156, s[24:27], 0 offen offset:1024 lds
    buffer_load_dwordx4 v156, s[24:27], 0 offen offset:2048 lds
    buffer_load_dwordx4 v156, s[24:27], 0 offen offset:3072 lds
    s_mov_b32 s20, s48
    s_and_b32 s21, s49, 0xffff
    s_mov_b32 s22, 1048576
    s_mov_b32 s23, 0x20000
    buffer_load_dwordx4 v[4:7], v146, s[20:23], s45 offen offset:0
    buffer_load_dwordx4 v[8:11], v146, s[20:23], s45 offen offset:64
    buffer_load_dwordx4 v[12:15], v146, s[20:23], s45 offen offset:128
    buffer_load_dwordx4 v[16:19], v146, s[20:23], s45 offen offset:192
    s_mov_b32 s16, s58
    s_and_b32 s17, s59, 0xffff
    s_mov_b32 s18, 1048576
    s_mov_b32 s19, 0x20000
    s_mov_b32 s72, s60
    s_and_b32 s73, s61, 0xffff
    s_mov_b32 s74, 256
    s_mov_b32 s75, 0x20000
    s_mov_b32 s67, 0
    v_lshlrev_b32 v158, 4, v1
    v_and_b32 v144, 7, v3
    v_lshlrev_b32 v144, 1, v144
    v_xor_b32 v144, v144, v2
    v_lshlrev_b32 v144, 4, v144
    v_lshl_add_u32 v128, v3, 8, v144
    v_lshrrev_b32 v144, 2, v3
    v_lshl_add_u32 v144, v2, 2, v144
    v_and_b32 v146, 7, v144
    v_lshlrev_b32 v146, 5, v146
    v_lshl_add_u32 v146, v144, 8, v146
    v_and_b32 v144, 3, v3
    v_lshl_add_u32 v129, v144, 3, v146
    v_add_u32 v129, 8192, v129
    v_lshlrev_b32 v151, 2, v1
    v_add_u32 v151, 131072, v151
    v_lshlrev_b32 v150, 2, v2
    v_lshlrev_b32 v157, 3, v1
    v_mov_b32 v155, 0xd0800000
    v_mov_b32 v147, 2048
    v_sub_u32 v70, 7, v64
    v_sub_u32 v71, 7, v65
    v_and_b32 v146, 56, v1
    s_lshl_b32 s44, s35, 3
    s_waitcnt vmcnt(8)
    v_cmp_gt_i32 vcc, 1, v66
    v_cmp_gt_i32 s[70:71], 1, v67
    v_min_i32 v66, v66, v147
    v_min_i32 v67, v67, v147
    v_cndmask_b32 v144, v66, v147, vcc
    v_cndmask_b32 v145, v67, v147, s[70:71]
    v_add_u32 v144, 15, v144
    v_add_u32 v145, 15, v145
    v_lshrrev_b32 v74, 4, v144
    v_lshrrev_b32 v69, 4, v145
    v_add_u32 v144, 1, v74
    v_add_u32 v145, 1, v69
    v_lshrrev_b32 v68, 1, v144
    v_lshrrev_b32 v145, 1, v145
    v_lshl_add_u32 v70, v68, 3, v70
    v_lshl_add_u32 v71, v145, 3, v71
    v_cmp_gt_u32 s[70:71], v71, v70
    v_readlane_b32 s83, v68, s44
    v_readlane_b32 s85, v66, s44
    v_lshrrev_b64 v[72:73], v146, s[70:71]
    v_readlane_b32 s87, v74, s44
    v_and_b32 v72, 0xff, v72
    v_bcnt_u32_b32 v72, v72, 0
    s_nop 0
    v_readlane_b32 s45, v72, s44
    s_nop 1
    s_sub_u32 s46, 7, s45
    v_cmp_eq_u32 s[70:71], s46, v72
    s_nop 1
    s_ff1_i32_b64 s46, s[70:71]
    s_lshr_b32 s30, s46, 3
    s_and_b32 s30, s30, 7
    v_readlane_b32 s84, v68, s46
    v_readlane_b32 s29, v74, s46
    s_nop 1
    s_sub_i32 s31, s84, s83
    s_bitcmp1_b32 0xa2222222, s36
    s_cselect_b32 s46, 38, 64
    s_cmp_eq_u32 s36, 31
    s_cselect_b32 s46, 51, s46
    s_mul_i32 s31, s31, s46
    s_ashr_i32 s31, s31, 6
    s_mul_i32 s46, s83, 14
    s_lshr_b32 s46, s46, 4
    s_sub_i32 s46, s46, 3
    s_min_i32 s31, s31, s46
    s_sub_i32 s46, 64, s83
    s_min_i32 s31, s31, s46
    s_cmp_lt_i32 s31, 12
    s_cselect_b32 s31, 0, s31
    s_cmp_ge_u32 s30, 6
    s_addc_u32 s65, s3, s30
    s_and_b32 s65, s65, 31
    s_bitcmp1_b32 0xa2222222, s65
    s_cselect_b32 s31, s31, 0
    s_cmp_lt_u32 s45, 4
    s_cselect_b32 s31, 0, s31
    s_add_u32 s33, s83, s31
    s_mul_i32 s44, s33, 17
    s_lshr_b32 s44, s44, 8
    s_add_u32 s44, s44, 3
    s_sub_i32 s44, s33, s44
    s_max_i32 s44, s44, 1
    v_cvt_f32_u32 v144, s44
    v_cvt_f32_u32 v145, s31
    v_rcp_f32 v144, v144
    v_cvt_f32_u32 v146, v1
    v_mul_f32 v144, v144, v145
    v_add_f32 v64, -2.0, v146
    v_add_f32 v65, -1.0, v146
    v_mov_b32 v147, 0x3c23d70a
    v_fma_f32 v64, v64, v144, v147
    v_fma_f32 v65, v65, v144, v147
    v_med3_f32 v64, v64, 0, v145
    v_med3_f32 v65, v65, 0, v145
    v_cvt_u32_f32 v64, v64
    v_cvt_u32_f32 v65, v65
    v_cmp_gt_u32 vcc, v65, v64
    v_sub_u32 v64, v1, v64
    v_mov_b32 v147, -1
    s_cmp_lg_u32 s42, 0
    v_cndmask_b32 v154, v64, v147, vcc
    s_cbranch_scc1 L_notab
    v_cvt_f32_u32 v144, s33
    v_cvt_f32_u32 v145, s84
    v_rcp_f32 v144, v144
    v_mov_b32 v147, 0x3d8f5c29
    s_sub_u32 s46, s84, 1
    v_fma_f32 v144, v144, v146, v147
    v_mul_f32 v144, v144, v145
    v_add_f32 v144, 0x00000000, v144
    v_cvt_u32_f32 v66, v144
    v_min_u32 v66, s46, v66
    v_cndmask_b32 v64, v64, v66, vcc
    v_add_u32 v71, 1, v64
    v_mov_b32 v144, s35
    v_mov_b32 v145, s30
    v_cndmask_b32 v67, v144, v145, vcc
    v_lshlrev_b32 v67, 9, v67
    v_lshl_add_u32 v144, v71, 3, v67
    v_lshl_add_u32 v145, v64, 3, v67
    v_and_b32 v144, 0xff8, v144
    v_and_b32 v145, 0xff8, v145
    v_add_u32 v144, 135168, v144
    v_add_u32 v145, 135168, v145
    s_waitcnt vmcnt(4)
    ds_read_b64 v[76:77], v144
    ds_read_b64 v[78:79], v145
    v_mov_b32 v144, s87
    v_mov_b32 v145, s29
    v_cndmask_b32 v68, v144, v145, vcc
    s_lshl_b32 s70, s65, 8
    s_lshl_b32 s71, s36, 8
    v_mov_b32 v146, s70
    v_mov_b32 v147, s71
    v_cndmask_b32 v70, v147, v146, vcc
    s_lshr_b64 s[70:71], vcc, 1
    v_mov_b32 v144, 1
    v_cndmask_b32 v144, v144, 2, s[70:71]
    v_cndmask_b32 v144, v144, 0, vcc
    v_add_u32 v144, v144, v1
    v_lshlrev_b32 v144, 14, v144
    ds_write_b32 v151, v144 offset:3584
    v_mov_b32 v146, vcc_lo
    v_mov_b32 v147, vcc_hi
    v_lshlrev_b32 v71, 1, v71
    v_lshl_add_u32 v64, v64, 1, 1
    v_add_u32 v66, 1, v71
    v_cmp_gt_u32 s[8:9], v68, v71
    v_cmp_gt_u32 s[10:11], v68, v66
    v_cmp_gt_u32 vcc, v68, v64
    v_readlane_b32 s46, v69, 0
    v_readlane_b32 s70, v69, 1
    s_nop 0
    s_add_u32 s46, s46, s70
    v_readlane_b32 s70, v69, 2
    s_nop 0
    s_add_u32 s46, s46, s70
    v_readlane_b32 s70, v69, 3
    s_nop 0
    s_add_u32 s46, s46, s70
    v_readlane_b32 s70, v69, 4
    s_nop 0
    s_add_u32 s46, s46, s70
    v_readlane_b32 s70, v69, 5
    s_nop 0
    s_add_u32 s46, s46, s70
    v_readlane_b32 s70, v69, 6
    s_nop 0
    s_add_u32 s46, s46, s70
    v_readlane_b32 s70, v69, 7
    s_nop 0
    s_add_u32 s46, s46, s70
    s_mul_i32 s70, s31, 36
    s_lshl_b32 s71, s87, 4
    s_add_u32 s70, s70, s71
    v_cvt_f32_u32 v144, s46
    v_cvt_f32_u32 v145, s70
    v_rcp_f32 v144, v144
    v_mul_f32 v145, 0x43233333, v145
    v_mul_f32 v144, v144, v145
    v_mul_f32 v145, 0x3f9c28f6, v144
    v_mul_f32 v144, 0x3f866666, v144
    v_add_f32 v145, 0xc28bb2ff, v145
    v_add_f32 v144, 0xc1828f5c, v144
    v_max_f32 v144, v144, v145
    s_getreg_b32 s70, hwreg(HW_REG_XCC_ID, 0, 3)
    s_lshl_b32 s70, s70, 2
    s_lshr_b32 s70, 0x2c7d1b6b, s70
    s_and_b32 s70, s70, 15
    v_cvt_f32_u32 v145, s70
    v_mov_b32 v148, 0x3f7ae148
    v_fmac_f32 v148, 0x3b23d70a, v145
    v_mul_f32 v144, v144, v148
    s_bitcmp1_b32 0xa2222222, s36
    s_cselect_b32 s70, 0x3f828f5c, 1.0
    v_mul_f32 v144, s70, v144
    v_max_f32 v144, 0, v144
    v_cvt_u32_f32 v145, v144
    v_cvt_f32_u32 v144, s33
    v_rcp_f32 v144, v144
    v_readfirstlane_b32 s82, v145
    v_mul_f32 v144, 0x477f0000, v144
    v_cvt_u32_f32 v144, v144
    s_mov_b32 s67, 1
    v_readfirstlane_b32 s94, v144
    s_lshr_b32 s80, s3, 3
    v_mov_b32 v159, 0x01010101
    s_mov_b32 s95, 0
    v_mov_b32 v144, s33
    v_mov_b32 v148, 134912
    s_mov_b64 exec, 1
    ds_write_b128 v148, v[144:147]
    s_mov_b64 exec, -1
    v_add_u32 v148, 133632, v156
    v_mov_b32 v149, 134742016
    s_waitcnt lgkmcnt(0)
    v_lshl_add_u32 v76, v76, 17, v70
    v_lshl_add_u32 v77, v77, 17, v70
    v_lshl_add_u32 v78, v78, 17, v70
    v_lshl_add_u32 v79, v79, 17, v70
    v_cndmask_b32 v76, v149, v76, s[8:9]
    v_cndmask_b32 v77, v149, v77, s[10:11]
    v_cndmask_b32 v79, v149, v79, vcc
    ds_write_b128 v148, v[76:79]
    s_waitcnt lgkmcnt(0)
L_notab:
    s_barrier
    s_mov_b32 s37, s42
    s_mov_b32 s40, 0
    v_mov_b32 v20, 0
    v_mov_b32 v21, 0
    v_mov_b32 v22, 0
    v_mov_b32 v23, 0
    v_mov_b32 v24, 0
    v_mov_b32 v25, 0
    v_mov_b32 v26, 0
    v_mov_b32 v27, 0
    v_mov_b32 v28, 0
    v_mov_b32 v29, 0
    v_mov_b32 v30, 0
    v_mov_b32 v31, 0
    v_mov_b32 v32, 0
    v_mov_b32 v33, 0
    v_mov_b32 v34, 0
    v_mov_b32 v35, 0
    v_mov_b32 v36, 0
    v_mov_b32 v37, 0
    v_mov_b32 v38, 0
    v_mov_b32 v39, 0
    v_mov_b32 v40, 0
    v_mov_b32 v41, 0
    v_mov_b32 v42, 0
    v_mov_b32 v43, 0
    v_mov_b32 v44, 0
    v_mov_b32 v45, 0
    v_mov_b32 v46, 0
    v_mov_b32 v47, 0
    v_mov_b32 v48, 0
    v_mov_b32 v49, 0
    v_mov_b32 v50, 0
    v_mov_b32 v51, 0
    v_mov_b32 v142, v155
    v_mov_b32 v143, 0
    v_add_u32 v156, 135168, v156
    v_add_u32 v157, 135168, v157
    s_waitcnt vmcnt(0) lgkmcnt(0)
L_ctile:
    s_cmp_ge_u32 s37, s33
    s_cbranch_scc1 L_cdone
    s_cmp_lg_u32 s67, 0
    s_cbranch_scc1 L_fb
L_fbret:
    v_readlane_b32 s64, v154, s37
    s_and_b32 s45, s37, 7
    s_lshl_b32 s44, s45, 8
    v_add_u32 v152, s44, v151
    s_add_u32 s46, s37, 1
    v_mov_b32 v147, s46
    s_lshl_b32 s41, s37, 1
    s_add_u32 s37, s37, 2
    s_cmp_eq_u32 s46, s33
    s_cbranch_scc1 L_last
    s_cmp_lt_i32 s64, 0
    s_cbranch_scc1 L_skip
    s_lshl_b32 s39, s45, 14
    s_max_u32 s41, s41, 1
    v_add_u32 v130, s39, v128
    v_add_u32 v134, s39, v129
    v_xor_b32 v131, 64, v130
    v_xor_b32 v132, 128, v130
    v_xor_b32 v133, 192, v130
    v_xor_b32 v135, 32, v134
    v_xor_b32 v136, 64, v134
    v_xor_b32 v137, 96, v134
    v_xor_b32 v138, 128, v134
    v_xor_b32 v139, 160, v134
    v_xor_b32 v140, 192, v134
    v_xor_b32 v141, 224, v134
    s_lshl_b32 s44, s64, 5
    s_sub_i32 s38, s85, s44
    s_cmp_ge_i32 s40, s41
    s_cbranch_scc1 L_ok_k
L_poll_k:
    ds_read_b32 v153, v151
    s_sub_u32 s43, s43, 1
    s_cbranch_scc1 L_end
    s_waitcnt lgkmcnt(0)
    v_readfirstlane_b32 s40, v153
    s_nop 0
    s_cmp_ge_i32 s40, s41
    s_cbranch_scc0 L_poll_k
L_ok_k:
    ds_read_b128 v[64:67], v130 offset:0
    ds_read_b128 v[80:83], v130 offset:4096
    ds_read_b128 v[68:71], v131 offset:0
    ds_read_b128 v[84:87], v131 offset:4096
    ds_read_b128 v[72:75], v132 offset:0
    ds_read_b128 v[88:91], v132 offset:4096
    ds_read_b128 v[76:79], v133 offset:0
    ds_read_b128 v[92:95], v133 offset:4096
    s_waitcnt lgkmcnt(7)
    v_mfma_f32_16x16x32_bf16 v[52:55], v[64:67], v[4:7], 0
    s_waitcnt lgkmcnt(6)
    v_mfma_f32_16x16x32_bf16 v[56:59], v[80:83], v[4:7], 0
    s_waitcnt lgkmcnt(5)
    v_mfma_f32_16x16x32_bf16 v[52:55], v[68:71], v[8:11], v[52:55]
    s_waitcnt lgkmcnt(4)
    v_mfma_f32_16x16x32_bf16 v[56:59], v[84:87], v[8:11], v[56:59]
    s_waitcnt lgkmcnt(3)
    v_mfma_f32_16x16x32_bf16 v[52:55], v[72:75], v[12:15], v[52:55]
    s_waitcnt lgkmcnt(2)
    v_mfma_f32_16x16x32_bf16 v[56:59], v[88:91], v[12:15], v[56:59]
    s_waitcnt lgkmcnt(1)
    v_mfma_f32_16x16x32_bf16 v[52:55], v[76:79], v[16:19], v[52:55]
    s_waitcnt lgkmcnt(0)
    v_mfma_f32_16x16x32_bf16 v[56:59], v[92:95], v[16:19], v[56:59]
    s_lshl1_add_u32 s41, s37, -1
    s_cmp_ge_i32 s38, 32
    s_nop 5
    s_cbranch_scc1 L_nomask
    s_sub_i32 s44, s38, 0
    v_cmp_gt_i32 vcc, s44, v150
    s_nop 1
    v_cndmask_b32 v52, v155, v52, vcc
    s_sub_i32 s44, s38, 1
    v_cmp_gt_i32 vcc, s44, v150
    s_nop 1
    v_cndmask_b32 v53, v155, v53, vcc
    s_sub_i32 s44, s38, 2
    v_cmp_gt_i32 vcc, s44, v150
    s_nop 1
    v_cndmask_b32 v54, v155, v54, vcc
    s_sub_i32 s44, s38, 3
    v_cmp_gt_i32 vcc, s44, v150
    s_nop 1
    v_cndmask_b32 v55, v155, v55, vcc
    s_sub_i32 s44, s38, 16
    v_cmp_gt_i32 vcc, s44, v150
    s_nop 1
    v_cndmask_b32 v56, v155, v56, vcc
    s_sub_i32 s44, s38, 17
    v_cmp_gt_i32 vcc, s44, v150
    s_nop 1
    v_cndmask_b32 v57, v155, v57, vcc
    s_sub_i32 s44, s38, 18
    v_cmp_gt_i32 vcc, s44, v150
    s_nop 1
    v_cndmask_b32 v58, v155, v58, vcc
    s_sub_i32 s44, s38, 19
    v_cmp_gt_i32 vcc, s44, v150
    s_nop 1
    v_cndmask_b32 v59, v155, v59, vcc
L_nomask:
    v_max3_f32 v144, v52, v53, v54
    v_max3_f32 v145, v55, v56, v57
    v_max3_f32 v144, v144, v58, v59
    v_max3_f32 v144, v144, v145, v142
    v_mov_b32 v145, v144
    s_nop 1
    v_permlane16_swap_b32 v144, v145
    v_max_f32 v144, v144, v145
    v_mov_b32 v145, v144
    s_nop 1
    v_permlane32_swap_b32 v144, v145
    v_max_f32 v144, v144, v145
    v_sub_f32 v145, v142, v144
    v_mul_f32 v146, s28, v144
    v_mul_f32 v145, s28, v145
    v_mov_b32 v142, v144
    v_exp_f32 v148, v145
    v_fma_f32 v52, v52, s28, -v146
    v_fma_f32 v53, v53, s28, -v146
    v_fma_f32 v54, v54, s28, -v146
    v_fma_f32 v55, v55, s28, -v146
    v_fma_f32 v56, v56, s28, -v146
    v_fma_f32 v57, v57, s28, -v146
    v_fma_f32 v58, v58, s28, -v146
    v_fma_f32 v59, v59, s28, -v146
    v_exp_f32 v52, v52
    v_exp_f32 v53, v53
    v_exp_f32 v54, v54
    v_exp_f32 v55, v55
    v_exp_f32 v56, v56
    v_exp_f32 v57, v57
    v_exp_f32 v58, v58
    v_exp_f32 v59, v59
    s_cmp_lt_u32 s37, s33
    s_nop 0
    v_add_f32 v144, v52, v53
    v_add_f32 v145, v54, v55
    v_add_f32 v146, v56, v57
    v_add_f32 v144, v144, v145
    v_add_f32 v145, v58, v59
    v_add_f32 v144, v144, v146
    v_add_f32 v144, v144, v145
    v_fma_f32 v143, v143, v148, v144
    s_cbranch_scc1 L_more
    v_mov_b32 v144, 1
    ds_write_b64 v157, v[142:143] offset:8192
    s_waitcnt lgkmcnt(0)
    ds_write_b32 v151, v144 offset:2304
L_more:
    v_pk_mul_f32 v[20:21], v[20:21], v[148:149] op_sel_hi:[1,0]
    v_pk_mul_f32 v[22:23], v[22:23], v[148:149] op_sel_hi:[1,0]
    v_pk_mul_f32 v[24:25], v[24:25], v[148:149] op_sel_hi:[1,0]
    v_pk_mul_f32 v[26:27], v[26:27], v[148:149] op_sel_hi:[1,0]
    v_pk_mul_f32 v[28:29], v[28:29], v[148:149] op_sel_hi:[1,0]
    v_pk_mul_f32 v[30:31], v[30:31], v[148:149] op_sel_hi:[1,0]
    v_pk_mul_f32 v[32:33], v[32:33], v[148:149] op_sel_hi:[1,0]
    v_pk_mul_f32 v[34:35], v[34:35], v[148:149] op_sel_hi:[1,0]
    v_pk_mul_f32 v[36:37], v[36:37], v[148:149] op_sel_hi:[1,0]
    v_pk_mul_f32 v[38:39], v[38:39], v[148:149] op_sel_hi:[1,0]
    v_pk_mul_f32 v[40:41], v[40:41], v[148:149] op_sel_hi:[1,0]
    v_pk_mul_f32 v[42:43], v[42:43], v[148:149] op_sel_hi:[1,0]
    v_pk_mul_f32 v[44:45], v[44:45], v[148:149] op_sel_hi:[1,0]
    v_pk_mul_f32 v[46:47], v[46:47], v[148:149] op_sel_hi:[1,0]
    v_pk_mul_f32 v[48:49], v[48:49], v[148:149] op_sel_hi:[1,0]
    v_pk_mul_f32 v[50:51], v[50:51], v[148:149] op_sel_hi:[1,0]
    v_cvt_pk_bf16_f32 v60, v52, v53
    v_cvt_pk_bf16_f32 v61, v54, v55
    v_cvt_pk_bf16_f32 v62, v56, v57
    v_cvt_pk_bf16_f32 v63, v58, v59
    s_cmp_ge_i32 s40, s41
    s_cbranch_scc1 L_ok_v
L_poll_v:
    ds_read_b32 v153, v151
    s_sub_u32 s43, s43, 1
    s_cbranch_scc1 L_end
    s_waitcnt lgkmcnt(0)
    v_readfirstlane_b32 s40, v153
    s_nop 0
    s_cmp_ge_i32 s40, s41
    s_cbranch_scc0 L_poll_v
L_ok_v:
    ds_read_b64_tr_b16 v[96:97], v134 offset:0
    ds_read_b64_tr_b16 v[98:99], v134 offset:4096
    ds_read_b64_tr_b16 v[100:101], v135 offset:0
    ds_read_b64_tr_b16 v[102:103], v135 offset:4096
    ds_read_b64_tr_b16 v[104:105], v136 offset:0
    ds_read_b64_tr_b16 v[106:107], v136 offset:4096
    ds_read_b64_tr_b16 v[108:109], v137 offset:0
    ds_read_b64_tr_b16 v[110:111], v137 offset:4096
    ds_read_b64_tr_b16 v[112:113], v138 offset:0
    ds_read_b64_tr_b16 v[114:115], v138 offset:4096
    s_waitcnt lgkmcnt(8)
    v_mfma_f32_16x16x32_bf16 v[20:23], v[96:99], v[60:63], v[20:23]
    ds_read_b64_tr_b16 v[116:117], v139 offset:0
    ds_read_b64_tr_b16 v[118:119], v139 offset:4096
    s_waitcnt lgkmcnt(8)
    v_mfma_f32_16x16x32_bf16 v[24:27], v[100:103], v[60:63], v[24:27]
    ds_read_b64_tr_b16 v[120:121], v140 offset:0
    ds_read_b64_tr_b16 v[122:123], v140 offset:4096
    s_waitcnt lgkmcnt(8)
    v_mfma_f32_16x16x32_bf16 v[28:31], v[104:107], v[60:63], v[28:31]
    ds_read_b64_tr_b16 v[124:125], v141 offset:0
    ds_read_b64_tr_b16 v[126:127], v141 offset:4096
    s_waitcnt lgkmcnt(8)
    v_mfma_f32_16x16x32_bf16 v[32:35], v[108:111], v[60:63], v[32:35]
    s_waitcnt lgkmcnt(6)
    v_mfma_f32_16x16x32_bf16 v[36:39], v[112:115], v[60:63], v[36:39]
    s_waitcnt lgkmcnt(4)
    v_mfma_f32_16x16x32_bf16 v[40:43], v[116:119], v[60:63], v[40:43]
    s_waitcnt lgkmcnt(2)
    v_mfma_f32_16x16x32_bf16 v[44:47], v[120:123], v[60:63], v[44:47]
    s_waitcnt lgkmcnt(0)
    ds_write_b32 v152, v147 offset:256
    v_mfma_f32_16x16x32_bf16 v[48:51], v[124:127], v[60:63], v[48:51]
    s_branch L_ctile
L_skip:
    ds_write_b32 v152, v147 offset:256
    s_branch L_ctile
L_fb:
    s_waitcnt vmcnt(0)
    s_add_u32 s44, s37, 5
    s_cmp_gt_u32 s44, s33
    s_cbranch_scc1 L_fbpost
    s_cmp_lt_u32 s37, 6
    s_cbranch_scc1 L_fbpost
    v_dot4_u32_u8 v144, v160, v159, 0
    v_dot4_u32_u8 v144, v161, v159, v144
    v_dot4_u32_u8 v144, v162, v159, v144
    v_dot4_u32_u8 v144, v163, v159, v144
    s_mul_i32 s45, s94, 16
    s_lshr_b32 s45, s45, 4
    s_nop 1
    v_readfirstlane_b32 s44, v144
    v_readlane_b32 s70, v144, 1
    s_nop 0
    s_add_u32 s44, s44, s70
    s_sub_i32 s45, s45, s95
    s_lshl_b32 s44, s44, 3
    s_add_i32 s44, s44, s45
    s_abs_i32 s45, s44
    s_cmp_gt_u32 s45, 7833
    s_cselect_b32 s44, 0, s44
    s_mul_i32 s44, s44, 1280
    s_ashr_i32 s44, s44, 16
    s_min_i32 s44, s44, 48
    s_max_i32 s44, s44, -48
    s_add_i32 s44, s44, s82
    s_max_i32 s44, s44, 0
    v_mov_b32 v145, s44
    s_mov_b64 exec, 1
    ds_write_b32 v151, v145 offset:3844
L_fbpost:
    s_mov_b64 exec, 1
    s_mul_i32 s95, s37, s94
    s_add_u32 s44, s95, 128
    s_lshr_b32 s44, s44, 8
    v_mov_b32 v144, s44
    buffer_store_byte v144, v158, s[72:75], s80 offen
    s_mov_b64 exec, 3
    buffer_load_dwordx4 v[160:163], v158, s[72:75], 0 offen sc1
    s_mov_b64 exec, -1
    s_branch L_fbret
L_cdone:
    v_mov_b32 v146, 1
    s_nop 4
    ds_write_b128 v156, v[20:23] offset:0
    ds_write_b128 v156, v[24:27] offset:1024
    ds_write_b128 v156, v[28:31] offset:2048
    ds_write_b128 v156, v[32:35] offset:3072
    ds_write_b128 v156, v[36:39] offset:4096
    ds_write_b128 v156, v[40:43] offset:5120
    ds_write_b128 v156, v[44:47] offset:6144
    ds_write_b128 v156, v[48:51] offset:7168
    ds_write_b64 v157, v[142:143] offset:8192
    s_waitcnt lgkmcnt(0)
    ds_write_b32 v151, v146 offset:2304
    s_barrier
    s_endpgm
L_last:
    s_lshl_b32 s39, s45, 14
    s_max_u32 s41, s41, 1
    v_add_u32 v130, s39, v128
    v_add_u32 v134, s39, v129
    v_xor_b32 v131, 64, v130
    v_xor_b32 v132, 128, v130
    v_xor_b32 v133, 192, v130
    v_xor_b32 v135, 32, v134
    v_xor_b32 v136, 64, v134
    v_xor_b32 v137, 96, v134
    v_xor_b32 v138, 128, v134
    v_xor_b32 v139, 160, v134
    v_xor_b32 v140, 192, v134
    v_xor_b32 v141, 224, v134
    s_lshl_b32 s44, s64, 5
    s_sub_i32 s38, s85, s44
    v_and_b32 v146, 1, v2
    v_lshlrev_b32 v146, 5, v146
    v_lshrrev_b32 v147, 1, v2
    v_lshl_add_u32 v146, v147, 4, v146
    v_lshl_add_u32 v152, v3, 8, v146
    s_lshl_b32 s46, s2, 12
    s_sub_i32 s44, s38, 0
    v_cmp_gt_i32 s[8:9], s44, v150
    s_sub_i32 s44, s38, 1
    v_cmp_gt_i32 s[10:11], s44, v150
    s_sub_i32 s44, s38, 2
    v_cmp_gt_i32 s[12:13], s44, v150
    s_sub_i32 s44, s38, 3
    v_cmp_gt_i32 s[14:15], s44, v150
    s_sub_i32 s44, s38, 16
    v_cmp_gt_i32 s[20:21], s44, v150
    s_sub_i32 s44, s38, 17
    v_cmp_gt_i32 s[22:23], s44, v150
    s_sub_i32 s44, s38, 18
    v_cmp_gt_i32 s[24:25], s44, v150
    s_sub_i32 s44, s38, 19
    v_cmp_gt_i32 s[26:27], s44, v150
    s_cmp_ge_i32 s40, s41
    s_cbranch_scc1 L_ok_kl
L_poll_kl:
    ds_read_b32 v153, v151
    s_sub_u32 s43, s43, 1
    s_cbranch_scc1 L_end
    s_waitcnt lgkmcnt(0)
    v_readfirstlane_b32 s40, v153
    s_nop 0
    s_cmp_ge_i32 s40, s41
    s_cbranch_scc0 L_poll_kl
L_ok_kl:
    ds_read_b128 v[64:67], v130 offset:0
    ds_read_b128 v[80:83], v130 offset:4096
    ds_read_b128 v[68:71], v131 offset:0
    ds_read_b128 v[84:87], v131 offset:4096
    ds_read_b128 v[72:75], v132 offset:0
    ds_read_b128 v[88:91], v132 offset:4096
    ds_read_b128 v[76:79], v133 offset:0
    ds_read_b128 v[92:95], v133 offset:4096
    s_waitcnt lgkmcnt(7)
    v_mfma_f32_16x16x32_bf16 v[52:55], v[64:67], v[4:7], 0
    s_waitcnt lgkmcnt(6)
    v_mfma_f32_16x16x32_bf16 v[56:59], v[80:83], v[4:7], 0
    s_waitcnt lgkmcnt(5)
    v_mfma_f32_16x16x32_bf16 v[52:55], v[68:71], v[8:11], v[52:55]
    s_waitcnt lgkmcnt(4)
    v_mfma_f32_16x16x32_bf16 v[56:59], v[84:87], v[8:11], v[56:59]
    s_waitcnt lgkmcnt(3)
    v_mfma_f32_16x16x32_bf16 v[52:55], v[72:75], v[12:15], v[52:55]
    s_waitcnt lgkmcnt(2)
    v_mfma_f32_16x16x32_bf16 v[56:59], v[88:91], v[12:15], v[56:59]
    s_waitcnt lgkmcnt(1)
    v_mfma_f32_16x16x32_bf16 v[52:55], v[76:79], v[16:19], v[52:55]
    s_waitcnt lgkmcnt(0)
    v_mfma_f32_16x16x32_bf16 v[56:59], v[92:95], v[16:19], v[56:59]
L_pollxa:
    ds_read_b32 v153, v151 offset:2304
    s_sub_u32 s43, s43, 1
    s_cbranch_scc1 L_end
    s_waitcnt lgkmcnt(0)
    v_readfirstlane_b32 s44, v153
    s_nop 0
    s_cmp_lt_u32 s44, 1
    s_cbranch_scc1 L_pollxa
    ds_read_b64 v[168:169], v157 offset:8192
    v_cndmask_b32 v52, v155, v52, s[8:9]
    v_cndmask_b32 v53, v155, v53, s[10:11]
    v_cndmask_b32 v54, v155, v54, s[12:13]
    v_cndmask_b32 v55, v155, v55, s[14:15]
    v_cndmask_b32 v56, v155, v56, s[20:21]
    v_cndmask_b32 v57, v155, v57, s[22:23]
    v_cndmask_b32 v58, v155, v58, s[24:25]
    v_cndmask_b32 v59, v155, v59, s[26:27]
    v_max3_f32 v144, v52, v53, v54
    v_max3_f32 v145, v55, v56, v57
    v_max3_f32 v144, v144, v58, v59
    v_max3_f32 v144, v144, v145, v142
    v_mov_b32 v145, v144
    s_nop 1
    v_permlane16_swap_b32 v144, v145
    v_max_f32 v144, v144, v145
    v_mov_b32 v145, v144
    s_nop 1
    v_permlane32_swap_b32 v144, v145
    s_waitcnt lgkmcnt(0)
    v_max3_f32 v144, v144, v145, v168
    v_sub_f32 v170, v168, v144
    v_sub_f32 v145, v142, v144
    v_mul_f32 v146, s28, v144
    v_mul_f32 v145, s28, v145
    v_mul_f32 v170, s28, v170
    v_exp_f32 v148, v145
    v_exp_f32 v170, v170
    v_fma_f32 v52, v52, s28, -v146
    v_fma_f32 v53, v53, s28, -v146
    v_fma_f32 v54, v54, s28, -v146
    v_fma_f32 v55, v55, s28, -v146
    v_fma_f32 v56, v56, s28, -v146
    v_fma_f32 v57, v57, s28, -v146
    v_fma_f32 v58, v58, s28, -v146
    v_fma_f32 v59, v59, s28, -v146
    v_exp_f32 v52, v52
    v_exp_f32 v53, v53
    v_exp_f32 v54, v54
    v_exp_f32 v55, v55
    v_exp_f32 v56, v56
    v_exp_f32 v57, v57
    v_exp_f32 v58, v58
    v_exp_f32 v59, v59
    v_mul_f32 v143, v143, v148
    v_fma_f32 v143, v169, v170, v143
    v_add_f32 v144, v52, v53
    v_add_f32 v145, v54, v55
    v_add_f32 v146, v56, v57
    v_add_f32 v144, v144, v145
    v_add_f32 v145, v58, v59
    v_add_f32 v144, v144, v146
    v_add_f32 v144, v144, v145
    v_add_f32 v144, v144, v143
    v_mov_b32 v145, v144
    s_nop 1
    v_permlane16_swap_b32 v144, v145
    v_add_f32 v144, v144, v145
    v_mov_b32 v145, v144
    s_nop 1
    v_permlane32_swap_b32 v144, v145
    v_add_f32 v144, v144, v145
    v_rcp_f32 v146, v144
    s_nop 0
    v_mul_f32 v148, v148, v146
    v_mul_f32 v170, v170, v146
    v_pk_mul_f32 v[52:53], v[52:53], v[146:147] op_sel_hi:[1,0]
    v_pk_mul_f32 v[54:55], v[54:55], v[146:147] op_sel_hi:[1,0]
    v_pk_mul_f32 v[56:57], v[56:57], v[146:147] op_sel_hi:[1,0]
    v_pk_mul_f32 v[58:59], v[58:59], v[146:147] op_sel_hi:[1,0]
    v_cvt_pk_bf16_f32 v60, v52, v53
    v_cvt_pk_bf16_f32 v61, v54, v55
    v_cvt_pk_bf16_f32 v62, v56, v57
    v_cvt_pk_bf16_f32 v63, v58, v59
    v_pk_mul_f32 v[20:21], v[20:21], v[148:149] op_sel_hi:[1,0]
    v_pk_mul_f32 v[22:23], v[22:23], v[148:149] op_sel_hi:[1,0]
    v_pk_mul_f32 v[24:25], v[24:25], v[148:149] op_sel_hi:[1,0]
    v_pk_mul_f32 v[26:27], v[26:27], v[148:149] op_sel_hi:[1,0]
    v_pk_mul_f32 v[28:29], v[28:29], v[148:149] op_sel_hi:[1,0]
    v_pk_mul_f32 v[30:31], v[30:31], v[148:149] op_sel_hi:[1,0]
    v_pk_mul_f32 v[32:33], v[32:33], v[148:149] op_sel_hi:[1,0]
    v_pk_mul_f32 v[34:35], v[34:35], v[148:149] op_sel_hi:[1,0]
    v_pk_mul_f32 v[36:37], v[36:37], v[148:149] op_sel_hi:[1,0]
    v_pk_mul_f32 v[38:39], v[38:39], v[148:149] op_sel_hi:[1,0]
    v_pk_mul_f32 v[40:41], v[40:41], v[148:149] op_sel_hi:[1,0]
    v_pk_mul_f32 v[42:43], v[42:43], v[148:149] op_sel_hi:[1,0]
    v_pk_mul_f32 v[44:45], v[44:45], v[148:149] op_sel_hi:[1,0]
    v_pk_mul_f32 v[46:47], v[46:47], v[148:149] op_sel_hi:[1,0]
    v_pk_mul_f32 v[48:49], v[48:49], v[148:149] op_sel_hi:[1,0]
    v_pk_mul_f32 v[50:51], v[50:51], v[148:149] op_sel_hi:[1,0]
    s_barrier
    ds_read_b64_tr_b16 v[96:97], v134 offset:0
    ds_read_b64_tr_b16 v[98:99], v134 offset:4096
    ds_read_b64_tr_b16 v[100:101], v135 offset:0
    ds_read_b64_tr_b16 v[102:103], v135 offset:4096
    ds_read_b64_tr_b16 v[104:105], v136 offset:0
    ds_read_b64_tr_b16 v[106:107], v136 offset:4096
    ds_read_b64_tr_b16 v[108:109], v137 offset:0
    ds_read_b64_tr_b16 v[110:111], v137 offset:4096
    ds_read_b64_tr_b16 v[112:113], v138 offset:0
    ds_read_b64_tr_b16 v[114:115], v138 offset:4096
    s_waitcnt lgkmcnt(8)
    v_mfma_f32_16x16x32_bf16 v[20:23], v[96:99], v[60:63], v[20:23]
    ds_read_b64_tr_b16 v[116:117], v139 offset:0
    ds_read_b64_tr_b16 v[118:119], v139 offset:4096
    s_waitcnt lgkmcnt(8)
    v_mfma_f32_16x16x32_bf16 v[24:27], v[100:103], v[60:63], v[24:27]
    ds_read_b64_tr_b16 v[120:121], v140 offset:0
    ds_read_b64_tr_b16 v[122:123], v140 offset:4096
    s_waitcnt lgkmcnt(8)
    v_mfma_f32_16x16x32_bf16 v[28:31], v[104:107], v[60:63], v[28:31]
    ds_read_b64_tr_b16 v[124:125], v141 offset:0
    ds_read_b64_tr_b16 v[126:127], v141 offset:4096
    s_waitcnt lgkmcnt(8)
    v_mfma_f32_16x16x32_bf16 v[32:35], v[108:111], v[60:63], v[32:35]
    ds_read_b128 v[64:67], v156 offset:0
    ds_read_b128 v[68:71], v156 offset:1024
    s_waitcnt lgkmcnt(8)
    v_mfma_f32_16x16x32_bf16 v[36:39], v[112:115], v[60:63], v[36:39]
    ds_read_b128 v[72:75], v156 offset:2048
    ds_read_b128 v[76:79], v156 offset:3072
    s_waitcnt lgkmcnt(8)
    v_mfma_f32_16x16x32_bf16 v[40:43], v[116:119], v[60:63], v[40:43]
    ds_read_b128 v[80:83], v156 offset:4096
    ds_read_b128 v[84:87], v156 offset:5120
    s_waitcnt lgkmcnt(8)
    v_mfma_f32_16x16x32_bf16 v[44:47], v[120:123], v[60:63], v[44:47]
    ds_read_b128 v[88:91], v156 offset:6144
    ds_read_b128 v[92:95], v156 offset:7168
    s_waitcnt lgkmcnt(8)
    v_mfma_f32_16x16x32_bf16 v[48:51], v[124:127], v[60:63], v[48:51]
    s_waitcnt lgkmcnt(6)
    v_pk_fma_f32 v[20:21], v[64:65], v[170:171], v[20:21] op_sel_hi:[1,0,1]
    v_pk_fma_f32 v[22:23], v[66:67], v[170:171], v[22:23] op_sel_hi:[1,0,1]
    v_pk_fma_f32 v[24:25], v[68:69], v[170:171], v[24:25] op_sel_hi:[1,0,1]
    v_pk_fma_f32 v[26:27], v[70:71], v[170:171], v[26:27] op_sel_hi:[1,0,1]
    v_cvt_pk_bf16_f32 v4, v20, v21
    v_cvt_pk_bf16_f32 v5, v22, v23
    v_cvt_pk_bf16_f32 v6, v24, v25
    v_cvt_pk_bf16_f32 v7, v26, v27
    s_nop 1
    v_permlane16_swap_b32 v4, v6
    v_permlane16_swap_b32 v5, v7
    buffer_store_dwordx4 v[4:7], v152, s[16:19], s46 offen offset:0
    s_waitcnt lgkmcnt(4)
    v_pk_fma_f32 v[28:29], v[72:73], v[170:171], v[28:29] op_sel_hi:[1,0,1]
    v_pk_fma_f32 v[30:31], v[74:75], v[170:171], v[30:31] op_sel_hi:[1,0,1]
    v_pk_fma_f32 v[32:33], v[76:77], v[170:171], v[32:33] op_sel_hi:[1,0,1]
    v_pk_fma_f32 v[34:35], v[78:79], v[170:171], v[34:35] op_sel_hi:[1,0,1]
    v_cvt_pk_bf16_f32 v8, v28, v29
    v_cvt_pk_bf16_f32 v9, v30, v31
    v_cvt_pk_bf16_f32 v10, v32, v33
    v_cvt_pk_bf16_f32 v11, v34, v35
    s_nop 1
    v_permlane16_swap_b32 v8, v10
    v_permlane16_swap_b32 v9, v11
    buffer_store_dwordx4 v[8:11], v152, s[16:19], s46 offen offset:64
    s_waitcnt lgkmcnt(2)
    v_pk_fma_f32 v[36:37], v[80:81], v[170:171], v[36:37] op_sel_hi:[1,0,1]
    v_pk_fma_f32 v[38:39], v[82:83], v[170:171], v[38:39] op_sel_hi:[1,0,1]
    v_pk_fma_f32 v[40:41], v[84:85], v[170:171], v[40:41] op_sel_hi:[1,0,1]
    v_pk_fma_f32 v[42:43], v[86:87], v[170:171], v[42:43] op_sel_hi:[1,0,1]
    v_cvt_pk_bf16_f32 v12, v36, v37
    v_cvt_pk_bf16_f32 v13, v38, v39
    v_cvt_pk_bf16_f32 v14, v40, v41
    v_cvt_pk_bf16_f32 v15, v42, v43
    s_nop 1
    v_permlane16_swap_b32 v12, v14
    v_permlane16_swap_b32 v13, v15
    buffer_store_dwordx4 v[12:15], v152, s[16:19], s46 offen offset:128
    s_waitcnt lgkmcnt(0)
    v_pk_fma_f32 v[44:45], v[88:89], v[170:171], v[44:45] op_sel_hi:[1,0,1]
    v_pk_fma_f32 v[46:47], v[90:91], v[170:171], v[46:47] op_sel_hi:[1,0,1]
    v_pk_fma_f32 v[48:49], v[92:93], v[170:171], v[48:49] op_sel_hi:[1,0,1]
    v_pk_fma_f32 v[50:51], v[94:95], v[170:171], v[50:51] op_sel_hi:[1,0,1]
    v_cvt_pk_bf16_f32 v16, v44, v45
    v_cvt_pk_bf16_f32 v17, v46, v47
    v_cvt_pk_bf16_f32 v18, v48, v49
    v_cvt_pk_bf16_f32 v19, v50, v51
    s_nop 1
    v_permlane16_swap_b32 v16, v18
    v_permlane16_swap_b32 v17, v19
    buffer_store_dwordx4 v[16:19], v152, s[16:19], s46 offen offset:192
L_end:
    s_endpgm
.p2align 8
L_var:
.p2align 8
    s_waitcnt vmcnt(7)
    buffer_load_dwordx4 v4, s[8:11], s40 offen offset:0 nt lds
    s_waitcnt vmcnt(7)
    buffer_load_dwordx4 v5, s[8:11], s40 offen offset:1024 nt lds
    s_waitcnt vmcnt(7)
    buffer_load_dwordx4 v6, s[8:11], s40 offen offset:2048 nt lds
    s_waitcnt vmcnt(7)
    buffer_load_dwordx4 v7, s[8:11], s40 offen offset:3072 nt lds
    s_add_u32 m0, m0, 4096
    s_waitcnt vmcnt(7)
    buffer_load_dwordx4 v4, s[8:11], s41 offen offset:0 nt lds
    s_waitcnt vmcnt(7)
    buffer_load_dwordx4 v5, s[8:11], s41 offen offset:1024 nt lds
    s_waitcnt vmcnt(7)
    buffer_load_dwordx4 v6, s[8:11], s41 offen offset:2048 nt lds
    s_waitcnt vmcnt(7)
    s_add_i32 s44, s38, 0
    v_mov_b32 v22, s44
    ds_write_b32 v19, v22
    buffer_load_dwordx4 v7, s[8:11], s41 offen offset:3072 nt lds
    s_mov_b32 m0, s39
    s_waitcnt vmcnt(7)
    buffer_load_dwordx4 v4, s[12:15], s31 offen offset:0 nt lds
    s_waitcnt vmcnt(7)
    buffer_load_dwordx4 v5, s[12:15], s31 offen offset:1024 nt lds
    s_waitcnt vmcnt(7)
    buffer_load_dwordx4 v6, s[12:15], s31 offen offset:2048 nt lds
    s_waitcnt vmcnt(7)
    buffer_load_dwordx4 v7, s[12:15], s31 offen offset:3072 nt lds
    s_add_u32 m0, m0, 4096
    s_waitcnt vmcnt(7)
    buffer_load_dwordx4 v4, s[12:15], s32 offen offset:0 nt lds
    s_waitcnt vmcnt(7)
    buffer_load_dwordx4 v5, s[12:15], s32 offen offset:1024 nt lds
    s_waitcnt vmcnt(7)
    buffer_load_dwordx4 v6, s[12:15], s32 offen offset:2048 nt lds
    s_waitcnt vmcnt(7)
    s_add_i32 s44, s38, 1
    v_mov_b32 v22, s44
    ds_write_b32 v19, v22
    buffer_load_dwordx4 v7, s[12:15], s32 offen offset:3072 nt lds
    s_branch L_next
.p2align 8
    s_waitcnt vmcnt(8)
    s_add_i32 s44, s38, -1
    v_mov_b32 v22, s44
    ds_write_b32 v19, v22
    buffer_load_dwordx4 v4, s[8:11], s40 offen offset:0 nt lds
    s_waitcnt vmcnt(8)
    buffer_load_dwordx4 v5, s[8:11], s40 offen offset:1024 nt lds
    s_waitcnt vmcnt(8)
    buffer_load_dwordx4 v6, s[8:11], s40 offen offset:2048 nt lds
    s_waitcnt vmcnt(8)
    buffer_load_dwordx4 v7, s[8:11], s40 offen offset:3072 nt lds
    s_add_u32 m0, m0, 4096
    s_waitcnt vmcnt(8)
    buffer_load_dwordx4 v4, s[8:11], s41 offen offset:0 nt lds
    s_waitcnt vmcnt(8)
    buffer_load_dwordx4 v5, s[8:11], s41 offen offset:1024 nt lds
    s_waitcnt vmcnt(8)
    buffer_load_dwordx4 v6, s[8:11], s41 offen offset:2048 nt lds
    s_waitcnt vmcnt(8)
    buffer_load_dwordx4 v7, s[8:11], s41 offen offset:3072 nt lds
    s_mov_b32 m0, s39
    s_waitcnt vmcnt(8)
    s_add_i32 s44, s38, 0
    v_mov_b32 v22, s44
    ds_write_b32 v19, v22
    buffer_load_dwordx4 v4, s[12:15], s31 offen offset:0 nt lds
    s_waitcnt vmcnt(8)
    buffer_load_dwordx4 v5, s[12:15], s31 offen offset:1024 nt lds
    s_waitcnt vmcnt(8)
    buffer_load_dwordx4 v6, s[12:15], s31 offen offset:2048 nt lds
    s_waitcnt vmcnt(8)
    buffer_load_dwordx4 v7, s[12:15], s31 offen offset:3072 nt lds
    s_add_u32 m0, m0, 4096
    s_waitcnt vmcnt(8)
    buffer_load_dwordx4 v4, s[12:15], s32 offen offset:0 nt lds
    s_waitcnt vmcnt(8)
    buffer_load_dwordx4 v5, s[12:15], s32 offen offset:1024 nt lds
    s_waitcnt vmcnt(8)
    buffer_load_dwordx4 v6, s[12:15], s32 offen offset:2048 nt lds
    s_waitcnt vmcnt(8)
    buffer_load_dwordx4 v7, s[12:15], s32 offen offset:3072 nt lds
    s_branch L_next
.p2align 8
    s_waitcnt vmcnt(9)
    buffer_load_dwordx4 v4, s[8:11], s40 offen offset:0 nt lds
    s_waitcnt vmcnt(9)
    s_add_i32 s44, s38, -1
    v_mov_b32 v22, s44
    ds_write_b32 v19, v22
    buffer_load_dwordx4 v5, s[8:11], s40 offen offset:1024 nt lds
    s_waitcnt vmcnt(9)
    buffer_load_dwordx4 v6, s[8:11], s40 offen offset:2048 nt lds
    s_waitcnt vmcnt(9)
    buffer_load_dwordx4 v7, s[8:11], s40 offen offset:3072 nt lds
    s_add_u32 m0, m0, 4096
    s_waitcnt vmcnt(9)
    buffer_load_dwordx4 v4, s[8:11], s41 offen offset:0 nt lds
    s_waitcnt vmcnt(9)
    buffer_load_dwordx4 v5, s[8:11], s41 offen offset:1024 nt lds
    s_waitcnt vmcnt(9)
    buffer_load_dwordx4 v6, s[8:11], s41 offen offset:2048 nt lds
    s_waitcnt vmcnt(9)
    buffer_load_dwordx4 v7, s[8:11], s41 offen offset:3072 nt lds
    s_mov_b32 m0, s39
    s_waitcnt vmcnt(9)
    buffer_load_dwordx4 v4, s[12:15], s31 offen offset:0 nt lds
    s_waitcnt vmcnt(9)
    s_add_i32 s44, s38, 0
    v_mov_b32 v22, s44
    ds_write_b32 v19, v22
    buffer_load_dwordx4 v5, s[12:15], s31 offen offset:1024 nt lds
    s_waitcnt vmcnt(9)
    buffer_load_dwordx4 v6, s[12:15], s31 offen offset:2048 nt lds
    s_waitcnt vmcnt(9)
    buffer_load_dwordx4 v7, s[12:15], s31 offen offset:3072 nt lds
    s_add_u32 m0, m0, 4096
    s_waitcnt vmcnt(9)
    buffer_load_dwordx4 v4, s[12:15], s32 offen offset:0 nt lds
    s_waitcnt vmcnt(9)
    buffer_load_dwordx4 v5, s[12:15], s32 offen offset:1024 nt lds
    s_waitcnt vmcnt(9)
    buffer_load_dwordx4 v6, s[12:15], s32 offen offset:2048 nt lds
    s_waitcnt vmcnt(9)
    buffer_load_dwordx4 v7, s[12:15], s32 offen offset:3072 nt lds
    s_branch L_next
.p2align 8
    s_waitcnt vmcnt(10)
    buffer_load_dwordx4 v4, s[8:11], s40 offen offset:0 nt lds
    s_waitcnt vmcnt(10)
    buffer_load_dwordx4 v5, s[8:11], s40 offen offset:1024 nt lds
    s_waitcnt vmcnt(10)
    s_add_i32 s44, s38, -1
    v_mov_b32 v22, s44
    ds_write_b32 v19, v22
    buffer_load_dwordx4 v6, s[8:11], s40 offen offset:2048 nt lds
    s_waitcnt vmcnt(10)
    buffer_load_dwordx4 v7, s[8:11], s40 offen offset:3072 nt lds
    s_add_u32 m0, m0, 4096
    s_waitcnt vmcnt(10)
    buffer_load_dwordx4 v4, s[8:11], s41 offen offset:0 nt lds
    s_waitcnt vmcnt(10)
    buffer_load_dwordx4 v5, s[8:11], s41 offen offset:1024 nt lds
    s_waitcnt vmcnt(10)
    buffer_load_dwordx4 v6, s[8:11], s41 offen offset:2048 nt lds
    s_waitcnt vmcnt(10)
    buffer_load_dwordx4 v7, s[8:11], s41 offen offset:3072 nt lds
    s_mov_b32 m0, s39
    s_waitcnt vmcnt(10)
    buffer_load_dwordx4 v4, s[12:15], s31 offen offset:0 nt lds
    s_waitcnt vmcnt(10)
    buffer_load_dwordx4 v5, s[12:15], s31 offen offset:1024 nt lds
    s_waitcnt vmcnt(10)
    s_add_i32 s44, s38, 0
    v_mov_b32 v22, s44
    ds_write_b32 v19, v22
    buffer_load_dwordx4 v6, s[12:15], s31 offen offset:2048 nt lds
    s_waitcnt vmcnt(10)
    buffer_load_dwordx4 v7, s[12:15], s31 offen offset:3072 nt lds
    s_add_u32 m0, m0, 4096
    s_waitcnt vmcnt(10)
    buffer_load_dwordx4 v4, s[12:15], s32 offen offset:0 nt lds
    s_waitcnt vmcnt(10)
    buffer_load_dwordx4 v5, s[12:15], s32 offen offset:1024 nt lds
    s_waitcnt vmcnt(10)
    buffer_load_dwordx4 v6, s[12:15], s32 offen offset:2048 nt lds
    s_waitcnt vmcnt(10)
    buffer_load_dwordx4 v7, s[12:15], s32 offen offset:3072 nt lds
    s_branch L_next
.p2align 8
    s_waitcnt vmcnt(11)
    buffer_load_dwordx4 v4, s[8:11], s40 offen offset:0 nt lds
    s_waitcnt vmcnt(11)
    buffer_load_dwordx4 v5, s[8:11], s40 offen offset:1024 nt lds
    s_waitcnt vmcnt(11)
    buffer_load_dwordx4 v6, s[8:11], s40 offen offset:2048 nt lds
    s_waitcnt vmcnt(11)
    s_add_i32 s44, s38, -1
    v_mov_b32 v22, s44
    ds_write_b32 v19, v22
    buffer_load_dwordx4 v7, s[8:11], s40 offen offset:3072 nt lds
    s_add_u32 m0, m0, 4096
    s_waitcnt vmcnt(11)
    buffer_load_dwordx4 v4, s[8:11], s41 offen offset:0 nt lds
    s_waitcnt vmcnt(11)
    buffer_load_dwordx4 v5, s[8:11], s41 offen offset:1024 nt lds
    s_waitcnt vmcnt(11)
    buffer_load_dwordx4 v6, s[8:11], s41 offen offset:2048 nt lds
    s_waitcnt vmcnt(11)
    buffer_load_dwordx4 v7, s[8:11], s41 offen offset:3072 nt lds
    s_mov_b32 m0, s39
    s_waitcnt vmcnt(11)
    buffer_load_dwordx4 v4, s[12:15], s31 offen offset:0 nt lds
    s_waitcnt vmcnt(11)
    buffer_load_dwordx4 v5, s[12:15], s31 offen offset:1024 nt lds
    s_waitcnt vmcnt(11)
    buffer_load_dwordx4 v6, s[12:15], s31 offen offset:2048 nt lds
    s_waitcnt vmcnt(11)
    s_add_i32 s44, s38, 0
    v_mov_b32 v22, s44
    ds_write_b32 v19, v22
    buffer_load_dwordx4 v7, s[12:15], s31 offen offset:3072 nt lds
    s_add_u32 m0, m0, 4096
    s_waitcnt vmcnt(11)
    buffer_load_dwordx4 v4, s[12:15], s32 offen offset:0 nt lds
    s_waitcnt vmcnt(11)
    buffer_load_dwordx4 v5, s[12:15], s32 offen offset:1024 nt lds
    s_waitcnt vmcnt(11)
    buffer_load_dwordx4 v6, s[12:15], s32 offen offset:2048 nt lds
    s_waitcnt vmcnt(11)
    buffer_load_dwordx4 v7, s[12:15], s32 offen offset:3072 nt lds
    s_branch L_next
.p2align 8
    s_waitcnt vmcnt(12)
    buffer_load_dwordx4 v4, s[8:11], s40 offen offset:0 nt lds
    s_waitcnt vmcnt(12)
    buffer_load_dwordx4 v5, s[8:11], s40 offen offset:1024 nt lds
    s_waitcnt vmcnt(12)
    buffer_load_dwordx4 v6, s[8:11], s40 offen offset:2048 nt lds
    s_waitcnt vmcnt(12)
    buffer_load_dwordx4 v7, s[8:11], s40 offen offset:3072 nt lds
    s_add_u32 m0, m0, 4096
    s_waitcnt vmcnt(12)
    s_add_i32 s44, s38, -1
    v_mov_b32 v22, s44
    ds_write_b32 v19, v22
    buffer_load_dwordx4 v4, s[8:11], s41 offen offset:0 nt lds
    s_waitcnt vmcnt(12)
    buffer_load_dwordx4 v5, s[8:11], s41 offen offset:1024 nt lds
    s_waitcnt vmcnt(12)
    buffer_load_dwordx4 v6, s[8:11], s41 offen offset:2048 nt lds
    s_waitcnt vmcnt(12)
    buffer_load_dwordx4 v7, s[8:11], s41 offen offset:3072 nt lds
    s_mov_b32 m0, s39
    s_waitcnt vmcnt(12)
    buffer_load_dwordx4 v4, s[12:15], s31 offen offset:0 nt lds
    s_waitcnt vmcnt(12)
    buffer_load_dwordx4 v5, s[12:15], s31 offen offset:1024 nt lds
    s_waitcnt vmcnt(12)
    buffer_load_dwordx4 v6, s[12:15], s31 offen offset:2048 nt lds
    s_waitcnt vmcnt(12)
    buffer_load_dwordx4 v7, s[12:15], s31 offen offset:3072 nt lds
    s_add_u32 m0, m0, 4096
    s_waitcnt vmcnt(12)
    s_add_i32 s44, s38, 0
    v_mov_b32 v22, s44
    ds_write_b32 v19, v22
    buffer_load_dwordx4 v4, s[12:15], s32 offen offset:0 nt lds
    s_waitcnt vmcnt(12)
    buffer_load_dwordx4 v5, s[12:15], s32 offen offset:1024 nt lds
    s_waitcnt vmcnt(12)
    buffer_load_dwordx4 v6, s[12:15], s32 offen offset:2048 nt lds
    s_waitcnt vmcnt(12)
    buffer_load_dwordx4 v7, s[12:15], s32 offen offset:3072 nt lds
    s_branch L_next
.p2align 8
    s_waitcnt vmcnt(13)
    buffer_load_dwordx4 v4, s[8:11], s40 offen offset:0 nt lds
    s_waitcnt vmcnt(13)
    buffer_load_dwordx4 v5, s[8:11], s40 offen offset:1024 nt lds
    s_waitcnt vmcnt(13)
    buffer_load_dwordx4 v6, s[8:11], s40 offen offset:2048 nt lds
    s_waitcnt vmcnt(13)
    buffer_load_dwordx4 v7, s[8:11], s40 offen offset:3072 nt lds
    s_add_u32 m0, m0, 4096
    s_waitcnt vmcnt(13)
    buffer_load_dwordx4 v4, s[8:11], s41 offen offset:0 nt lds
    s_waitcnt vmcnt(13)
    s_add_i32 s44, s38, -1
    v_mov_b32 v22, s44
    ds_write_b32 v19, v22
    buffer_load_dwordx4 v5, s[8:11], s41 offen offset:1024 nt lds
    s_waitcnt vmcnt(13)
    buffer_load_dwordx4 v6, s[8:11], s41 offen offset:2048 nt lds
    s_waitcnt vmcnt(13)
    buffer_load_dwordx4 v7, s[8:11], s41 offen offset:3072 nt lds
    s_mov_b32 m0, s39
    s_waitcnt vmcnt(13)
    buffer_load_dwordx4 v4, s[12:15], s31 offen offset:0 nt lds
    s_waitcnt vmcnt(13)
    buffer_load_dwordx4 v5, s[12:15], s31 offen offset:1024 nt lds
    s_waitcnt vmcnt(13)
    buffer_load_dwordx4 v6, s[12:15], s31 offen offset:2048 nt lds
    s_waitcnt vmcnt(13)
    buffer_load_dwordx4 v7, s[12:15], s31 offen offset:3072 nt lds
    s_add_u32 m0, m0, 4096
    s_waitcnt vmcnt(13)
    buffer_load_dwordx4 v4, s[12:15], s32 offen offset:0 nt lds
    s_waitcnt vmcnt(13)
    s_add_i32 s44, s38, 0
    v_mov_b32 v22, s44
    ds_write_b32 v19, v22
    buffer_load_dwordx4 v5, s[12:15], s32 offen offset:1024 nt lds
    s_waitcnt vmcnt(13)
    buffer_load_dwordx4 v6, s[12:15], s32 offen offset:2048 nt lds
    s_waitcnt vmcnt(13)
    buffer_load_dwordx4 v7, s[12:15], s32 offen offset:3072 nt lds
    s_branch L_next
.p2align 8
    s_waitcnt vmcnt(14)
    buffer_load_dwordx4 v4, s[8:11], s40 offen offset:0 nt lds
    s_waitcnt vmcnt(14)
    buffer_load_dwordx4 v5, s[8:11], s40 offen offset:1024 nt lds
    s_waitcnt vmcnt(14)
    buffer_load_dwordx4 v6, s[8:11], s40 offen offset:2048 nt lds
    s_waitcnt vmcnt(14)
    buffer_load_dwordx4 v7, s[8:11], s40 offen offset:3072 nt lds
    s_add_u32 m0, m0, 4096
    s_waitcnt vmcnt(14)
    buffer_load_dwordx4 v4, s[8:11], s41 offen offset:0 nt lds
    s_waitcnt vmcnt(14)
    buffer_load_dwordx4 v5, s[8:11], s41 offen offset:1024 nt lds
    s_waitcnt vmcnt(14)
    s_add_i32 s44, s38, -1
    v_mov_b32 v22, s44
    ds_write_b32 v19, v22
    buffer_load_dwordx4 v6, s[8:11], s41 offen offset:2048 nt lds
    s_waitcnt vmcnt(14)
    buffer_load_dwordx4 v7, s[8:11], s41 offen offset:3072 nt lds
    s_mov_b32 m0, s39
    s_waitcnt vmcnt(14)
    buffer_load_dwordx4 v4, s[12:15], s31 offen offset:0 nt lds
    s_waitcnt vmcnt(14)
    buffer_load_dwordx4 v5, s[12:15], s31 offen offset:1024 nt lds
    s_waitcnt vmcnt(14)
    buffer_load_dwordx4 v6, s[12:15], s31 offen offset:2048 nt lds
    s_waitcnt vmcnt(14)
    buffer_load_dwordx4 v7, s[12:15], s31 offen offset:3072 nt lds
    s_add_u32 m0, m0, 4096
    s_waitcnt vmcnt(14)
    buffer_load_dwordx4 v4, s[12:15], s32 offen offset:0 nt lds
    s_waitcnt vmcnt(14)
    buffer_load_dwordx4 v5, s[12:15], s32 offen offset:1024 nt lds
    s_waitcnt vmcnt(14)
    s_add_i32 s44, s38, 0
    v_mov_b32 v22, s44
    ds_write_b32 v19, v22
    buffer_load_dwordx4 v6, s[12:15], s32 offen offset:2048 nt lds
    s_waitcnt vmcnt(14)
    buffer_load_dwordx4 v7, s[12:15], s32 offen offset:3072 nt lds
    s_branch L_next
.p2align 8
    s_waitcnt vmcnt(15)
    buffer_load_dwordx4 v4, s[8:11], s40 offen offset:0 nt lds
    s_waitcnt vmcnt(15)
    buffer_load_dwordx4 v5, s[8:11], s40 offen offset:1024 nt lds
    s_waitcnt vmcnt(15)
    buffer_load_dwordx4 v6, s[8:11], s40 offen offset:2048 nt lds
    s_waitcnt vmcnt(15)
    buffer_load_dwordx4 v7, s[8:11], s40 offen offset:3072 nt lds
    s_add_u32 m0, m0, 4096
    s_waitcnt vmcnt(15)
    buffer_load_dwordx4 v4, s[8:11], s41 offen offset:0 nt lds
    s_waitcnt vmcnt(15)
    buffer_load_dwordx4 v5, s[8:11], s41 offen offset:1024 nt lds
    s_waitcnt vmcnt(15)
    buffer_load_dwordx4 v6, s[8:11], s41 offen offset:2048 nt lds
    s_waitcnt vmcnt(15)
    s_add_i32 s44, s38, -1
    v_mov_b32 v22, s44
    ds_write_b32 v19, v22
    buffer_load_dwordx4 v7, s[8:11], s41 offen offset:3072 nt lds
    s_mov_b32 m0, s39
    s_waitcnt vmcnt(15)
    buffer_load_dwordx4 v4, s[12:15], s31 offen offset:0 nt lds
    s_waitcnt vmcnt(15)
    buffer_load_dwordx4 v5, s[12:15], s31 offen offset:1024 nt lds
    s_waitcnt vmcnt(15)
    buffer_load_dwordx4 v6, s[12:15], s31 offen offset:2048 nt lds
    s_waitcnt vmcnt(15)
    buffer_load_dwordx4 v7, s[12:15], s31 offen offset:3072 nt lds
    s_add_u32 m0, m0, 4096
    s_waitcnt vmcnt(15)
    buffer_load_dwordx4 v4, s[12:15], s32 offen offset:0 nt lds
    s_waitcnt vmcnt(15)
    buffer_load_dwordx4 v5, s[12:15], s32 offen offset:1024 nt lds
    s_waitcnt vmcnt(15)
    buffer_load_dwordx4 v6, s[12:15], s32 offen offset:2048 nt lds
    s_waitcnt vmcnt(15)
    s_add_i32 s44, s38, 0
    v_mov_b32 v22, s44
    ds_write_b32 v19, v22
    buffer_load_dwordx4 v7, s[12:15], s32 offen offset:3072 nt lds
    s_branch L_next
.p2align 8
    s_waitcnt vmcnt(16)
    s_add_i32 s44, s38, -2
    v_mov_b32 v22, s44
    ds_write_b32 v19, v22
    buffer_load_dwordx4 v4, s[8:11], s40 offen offset:0 nt lds
    s_waitcnt vmcnt(16)
    buffer_load_dwordx4 v5, s[8:11], s40 offen offset:1024 nt lds
    s_waitcnt vmcnt(16)
    buffer_load_dwordx4 v6, s[8:11], s40 offen offset:2048 nt lds
    s_waitcnt vmcnt(16)
    buffer_load_dwordx4 v7, s[8:11], s40 offen offset:3072 nt lds
    s_add_u32 m0, m0, 4096
    s_waitcnt vmcnt(16)
    buffer_load_dwordx4 v4, s[8:11], s41 offen offset:0 nt lds
    s_waitcnt vmcnt(16)
    buffer_load_dwordx4 v5, s[8:11], s41 offen offset:1024 nt lds
    s_waitcnt vmcnt(16)
    buffer_load_dwordx4 v6, s[8:11], s41 offen offset:2048 nt lds
    s_waitcnt vmcnt(16)
    buffer_load_dwordx4 v7, s[8:11], s41 offen offset:3072 nt lds
    s_mov_b32 m0, s39
    s_waitcnt vmcnt(16)
    s_add_i32 s44, s38, -1
    v_mov_b32 v22, s44
    ds_write_b32 v19, v22
    buffer_load_dwordx4 v4, s[12:15], s31 offen offset:0 nt lds
    s_waitcnt vmcnt(16)
    buffer_load_dwordx4 v5, s[12:15], s31 offen offset:1024 nt lds
    s_waitcnt vmcnt(16)
    buffer_load_dwordx4 v6, s[12:15], s31 offen offset:2048 nt lds
    s_waitcnt vmcnt(16)
    buffer_load_dwordx4 v7, s[12:15], s31 offen offset:3072 nt lds
    s_add_u32 m0, m0, 4096
    s_waitcnt vmcnt(16)
    buffer_load_dwordx4 v4, s[12:15], s32 offen offset:0 nt lds
    s_waitcnt vmcnt(16)
    buffer_load_dwordx4 v5, s[12:15], s32 offen offset:1024 nt lds
    s_waitcnt vmcnt(16)
    buffer_load_dwordx4 v6, s[12:15], s32 offen offset:2048 nt lds
    s_waitcnt vmcnt(16)
    buffer_load_dwordx4 v7, s[12:15], s32 offen offset:3072 nt lds
    s_branch L_next
.p2align 8
    s_waitcnt vmcnt(17)
    buffer_load_dwordx4 v4, s[8:11], s40 offen offset:0 nt lds
    s_waitcnt vmcnt(17)
    s_add_i32 s44, s38, -2
    v_mov_b32 v22, s44
    ds_write_b32 v19, v22
    buffer_load_dwordx4 v5, s[8:11], s40 offen offset:1024 nt lds
    s_waitcnt vmcnt(17)
    buffer_load_dwordx4 v6, s[8:11], s40 offen offset:2048 nt lds
    s_waitcnt vmcnt(17)
    buffer_load_dwordx4 v7, s[8:11], s40 offen offset:3072 nt lds
    s_add_u32 m0, m0, 4096
    s_waitcnt vmcnt(17)
    buffer_load_dwordx4 v4, s[8:11], s41 offen offset:0 nt lds
    s_waitcnt vmcnt(17)
    buffer_load_dwordx4 v5, s[8:11], s41 offen offset:1024 nt lds
    s_waitcnt vmcnt(17)
    buffer_load_dwordx4 v6, s[8:11], s41 offen offset:2048 nt lds
    s_waitcnt vmcnt(17)
    buffer_load_dwordx4 v7, s[8:11], s41 offen offset:3072 nt lds
    s_mov_b32 m0, s39
    s_waitcnt vmcnt(17)
    buffer_load_dwordx4 v4, s[12:15], s31 offen offset:0 nt lds
    s_waitcnt vmcnt(17)
    s_add_i32 s44, s38, -1
    v_mov_b32 v22, s44
    ds_write_b32 v19, v22
    buffer_load_dwordx4 v5, s[12:15], s31 offen offset:1024 nt lds
    s_waitcnt vmcnt(17)
    buffer_load_dwordx4 v6, s[12:15], s31 offen offset:2048 nt lds
    s_waitcnt vmcnt(17)
    buffer_load_dwordx4 v7, s[12:15], s31 offen offset:3072 nt lds
    s_add_u32 m0, m0, 4096
    s_waitcnt vmcnt(17)
    buffer_load_dwordx4 v4, s[12:15], s32 offen offset:0 nt lds
    s_waitcnt vmcnt(17)
    buffer_load_dwordx4 v5, s[12:15], s32 offen offset:1024 nt lds
    s_waitcnt vmcnt(17)
    buffer_load_dwordx4 v6, s[12:15], s32 offen offset:2048 nt lds
    s_waitcnt vmcnt(17)
    buffer_load_dwordx4 v7, s[12:15], s32 offen offset:3072 nt lds
    s_branch L_next
.p2align 8
    s_waitcnt vmcnt(18)
    buffer_load_dwordx4 v4, s[8:11], s40 offen offset:0 nt lds
    s_waitcnt vmcnt(18)
    buffer_load_dwordx4 v5, s[8:11], s40 offen offset:1024 nt lds
    s_waitcnt vmcnt(18)
    s_add_i32 s44, s38, -2
    v_mov_b32 v22, s44
    ds_write_b32 v19, v22
    buffer_load_dwordx4 v6, s[8:11], s40 offen offset:2048 nt lds
    s_waitcnt vmcnt(18)
    buffer_load_dwordx4 v7, s[8:11], s40 offen offset:3072 nt lds
    s_add_u32 m0, m0, 4096
    s_waitcnt vmcnt(18)
    buffer_load_dwordx4 v4, s[8:11], s41 offen offset:0 nt lds
    s_waitcnt vmcnt(18)
    buffer_load_dwordx4 v5, s[8:11], s41 offen offset:1024 nt lds
    s_waitcnt vmcnt(18)
    buffer_load_dwordx4 v6, s[8:11], s41 offen offset:2048 nt lds
    s_waitcnt vmcnt(18)
    buffer_load_dwordx4 v7, s[8:11], s41 offen offset:3072 nt lds
    s_mov_b32 m0, s39
    s_waitcnt vmcnt(18)
    buffer_load_dwordx4 v4, s[12:15], s31 offen offset:0 nt lds
    s_waitcnt vmcnt(18)
    buffer_load_dwordx4 v5, s[12:15], s31 offen offset:1024 nt lds
    s_waitcnt vmcnt(18)
    s_add_i32 s44, s38, -1
    v_mov_b32 v22, s44
    ds_write_b32 v19, v22
    buffer_load_dwordx4 v6, s[12:15], s31 offen offset:2048 nt lds
    s_waitcnt vmcnt(18)
    buffer_load_dwordx4 v7, s[12:15], s31 offen offset:3072 nt lds
    s_add_u32 m0, m0, 4096
    s_waitcnt vmcnt(18)
    buffer_load_dwordx4 v4, s[12:15], s32 offen offset:0 nt lds
    s_waitcnt vmcnt(18)
    buffer_load_dwordx4 v5, s[12:15], s32 offen offset:1024 nt lds
    s_waitcnt vmcnt(18)
    buffer_load_dwordx4 v6, s[12:15], s32 offen offset:2048 nt lds
    s_waitcnt vmcnt(18)
    buffer_load_dwordx4 v7, s[12:15], s32 offen offset:3072 nt lds
    s_branch L_next
.p2align 8
    s_waitcnt vmcnt(19)
    buffer_load_dwordx4 v4, s[8:11], s40 offen offset:0 nt lds
    s_waitcnt vmcnt(19)
    buffer_load_dwordx4 v5, s[8:11], s40 offen offset:1024 nt lds
    s_waitcnt vmcnt(19)
    buffer_load_dwordx4 v6, s[8:11], s40 offen offset:2048 nt lds
    s_waitcnt vmcnt(19)
    s_add_i32 s44, s38, -2
    v_mov_b32 v22, s44
    ds_write_b32 v19, v22
    buffer_load_dwordx4 v7, s[8:11], s40 offen offset:3072 nt lds
    s_add_u32 m0, m0, 4096
    s_waitcnt vmcnt(19)
    buffer_load_dwordx4 v4, s[8:11], s41 offen offset:0 nt lds
    s_waitcnt vmcnt(19)
    buffer_load_dwordx4 v5, s[8:11], s41 offen offset:1024 nt lds
    s_waitcnt vmcnt(19)
    buffer_load_dwordx4 v6, s[8:11], s41 offen offset:2048 nt lds
    s_waitcnt vmcnt(19)
    buffer_load_dwordx4 v7, s[8:11], s41 offen offset:3072 nt lds
    s_mov_b32 m0, s39
    s_waitcnt vmcnt(19)
    buffer_load_dwordx4 v4, s[12:15], s31 offen offset:0 nt lds
    s_waitcnt vmcnt(19)
    buffer_load_dwordx4 v5, s[12:15], s31 offen offset:1024 nt lds
    s_waitcnt vmcnt(19)
    buffer_load_dwordx4 v6, s[12:15], s31 offen offset:2048 nt lds
    s_waitcnt vmcnt(19)
    s_add_i32 s44, s38, -1
    v_mov_b32 v22, s44
    ds_write_b32 v19, v22
    buffer_load_dwordx4 v7, s[12:15], s31 offen offset:3072 nt lds
    s_add_u32 m0, m0, 4096
    s_waitcnt vmcnt(19)
    buffer_load_dwordx4 v4, s[12:15], s32 offen offset:0 nt lds
    s_waitcnt vmcnt(19)
    buffer_load_dwordx4 v5, s[12:15], s32 offen offset:1024 nt lds
    s_waitcnt vmcnt(19)
    buffer_load_dwordx4 v6, s[12:15], s32 offen offset:2048 nt lds
    s_waitcnt vmcnt(19)
    buffer_load_dwordx4 v7, s[12:15], s32 offen offset:3072 nt lds
    s_branch L_next
.p2align 8
    s_waitcnt vmcnt(20)
    buffer_load_dwordx4 v4, s[8:11], s40 offen offset:0 nt lds
    s_waitcnt vmcnt(20)
    buffer_load_dwordx4 v5, s[8:11], s40 offen offset:1024 nt lds
    s_waitcnt vmcnt(20)
    buffer_load_dwordx4 v6, s[8:11], s40 offen offset:2048 nt lds
    s_waitcnt vmcnt(20)
    buffer_load_dwordx4 v7, s[8:11], s40 offen offset:3072 nt lds
    s_add_u32 m0, m0, 4096
    s_waitcnt vmcnt(20)
    s_add_i32 s44, s38, -2
    v_mov_b32 v22, s44
    ds_write_b32 v19, v22
    buffer_load_dwordx4 v4, s[8:11], s41 offen offset:0 nt lds
    s_waitcnt vmcnt(20)
    buffer_load_dwordx4 v5, s[8:11], s41 offen offset:1024 nt lds
    s_waitcnt vmcnt(20)
    buffer_load_dwordx4 v6, s[8:11], s41 offen offset:2048 nt lds
    s_waitcnt vmcnt(20)
    buffer_load_dwordx4 v7, s[8:11], s41 offen offset:3072 nt lds
    s_mov_b32 m0, s39
    s_waitcnt vmcnt(20)
    buffer_load_dwordx4 v4, s[12:15], s31 offen offset:0 nt lds
    s_waitcnt vmcnt(20)
    buffer_load_dwordx4 v5, s[12:15], s31 offen offset:1024 nt lds
    s_waitcnt vmcnt(20)
    buffer_load_dwordx4 v6, s[12:15], s31 offen offset:2048 nt lds
    s_waitcnt vmcnt(20)
    buffer_load_dwordx4 v7, s[12:15], s31 offen offset:3072 nt lds
    s_add_u32 m0, m0, 4096
    s_waitcnt vmcnt(20)
    s_add_i32 s44, s38, -1
    v_mov_b32 v22, s44
    ds_write_b32 v19, v22
    buffer_load_dwordx4 v4, s[12:15], s32 offen offset:0 nt lds
    s_waitcnt vmcnt(20)
    buffer_load_dwordx4 v5, s[12:15], s32 offen offset:1024 nt lds
    s_waitcnt vmcnt(20)
    buffer_load_dwordx4 v6, s[12:15], s32 offen offset:2048 nt lds
    s_waitcnt vmcnt(20)
    buffer_load_dwordx4 v7, s[12:15], s32 offen offset:3072 nt lds
    s_branch L_next
.p2align 8
    s_waitcnt vmcnt(21)
    buffer_load_dwordx4 v4, s[8:11], s40 offen offset:0 nt lds
    s_waitcnt vmcnt(21)
    buffer_load_dwordx4 v5, s[8:11], s40 offen offset:1024 nt lds
    s_waitcnt vmcnt(21)
    buffer_load_dwordx4 v6, s[8:11], s40 offen offset:2048 nt lds
    s_waitcnt vmcnt(21)
    buffer_load_dwordx4 v7, s[8:11], s40 offen offset:3072 nt lds
    s_add_u32 m0, m0, 4096
    s_waitcnt vmcnt(21)
    buffer_load_dwordx4 v4, s[8:11], s41 offen offset:0 nt lds
    s_waitcnt vmcnt(21)
    s_add_i32 s44, s38, -2
    v_mov_b32 v22, s44
    ds_write_b32 v19, v22
    buffer_load_dwordx4 v5, s[8:11], s41 offen offset:1024 nt lds
    s_waitcnt vmcnt(21)
    buffer_load_dwordx4 v6, s[8:11], s41 offen offset:2048 nt lds
    s_waitcnt vmcnt(21)
    buffer_load_dwordx4 v7, s[8:11], s41 offen offset:3072 nt lds
    s_mov_b32 m0, s39
    s_waitcnt vmcnt(21)
    buffer_load_dwordx4 v4, s[12:15], s31 offen offset:0 nt lds
    s_waitcnt vmcnt(21)
    buffer_load_dwordx4 v5, s[12:15], s31 offen offset:1024 nt lds
    s_waitcnt vmcnt(21)
    buffer_load_dwordx4 v6, s[12:15], s31 offen offset:2048 nt lds
    s_waitcnt vmcnt(21)
    buffer_load_dwordx4 v7, s[12:15], s31 offen offset:3072 nt lds
    s_add_u32 m0, m0, 4096
    s_waitcnt vmcnt(21)
    buffer_load_dwordx4 v4, s[12:15], s32 offen offset:0 nt lds
    s_waitcnt vmcnt(21)
    s_add_i32 s44, s38, -1
    v_mov_b32 v22, s44
    ds_write_b32 v19, v22
    buffer_load_dwordx4 v5, s[12:15], s32 offen offset:1024 nt lds
    s_waitcnt vmcnt(21)
    buffer_load_dwordx4 v6, s[12:15], s32 offen offset:2048 nt lds
    s_waitcnt vmcnt(21)
    buffer_load_dwordx4 v7, s[12:15], s32 offen offset:3072 nt lds
    s_branch L_next
.p2align 8
    s_waitcnt vmcnt(22)
    buffer_load_dwordx4 v4, s[8:11], s40 offen offset:0 nt lds
    s_waitcnt vmcnt(22)
    buffer_load_dwordx4 v5, s[8:11], s40 offen offset:1024 nt lds
    s_waitcnt vmcnt(22)
    buffer_load_dwordx4 v6, s[8:11], s40 offen offset:2048 nt lds
    s_waitcnt vmcnt(22)
    buffer_load_dwordx4 v7, s[8:11], s40 offen offset:3072 nt lds
    s_add_u32 m0, m0, 4096
    s_waitcnt vmcnt(22)
    buffer_load_dwordx4 v4, s[8:11], s41 offen offset:0 nt lds
    s_waitcnt vmcnt(22)
    buffer_load_dwordx4 v5, s[8:11], s41 offen offset:1024 nt lds
    s_waitcnt vmcnt(22)
    s_add_i32 s44, s38, -2
    v_mov_b32 v22, s44
    ds_write_b32 v19, v22
    buffer_load_dwordx4 v6, s[8:11], s41 offen offset:2048 nt lds
    s_waitcnt vmcnt(22)
    buffer_load_dwordx4 v7, s[8:11], s41 offen offset:3072 nt lds
    s_mov_b32 m0, s39
    s_waitcnt vmcnt(22)
    buffer_load_dwordx4 v4, s[12:15], s31 offen offset:0 nt lds
    s_waitcnt vmcnt(22)
    buffer_load_dwordx4 v5, s[12:15], s31 offen offset:1024 nt lds
    s_waitcnt vmcnt(22)
    buffer_load_dwordx4 v6, s[12:15], s31 offen offset:2048 nt lds
    s_waitcnt vmcnt(22)
    buffer_load_dwordx4 v7, s[12:15], s31 offen offset:3072 nt lds
    s_add_u32 m0, m0, 4096
    s_waitcnt vmcnt(22)
    buffer_load_dwordx4 v4, s[12:15], s32 offen offset:0 nt lds
    s_waitcnt vmcnt(22)
    buffer_load_dwordx4 v5, s[12:15], s32 offen offset:1024 nt lds
    s_waitcnt vmcnt(22)
    s_add_i32 s44, s38, -1
    v_mov_b32 v22, s44
    ds_write_b32 v19, v22
    buffer_load_dwordx4 v6, s[12:15], s32 offen offset:2048 nt lds
    s_waitcnt vmcnt(22)
    buffer_load_dwordx4 v7, s[12:15], s32 offen offset:3072 nt lds
    s_branch L_next
.p2align 8
    s_waitcnt vmcnt(23)
    buffer_load_dwordx4 v4, s[8:11], s40 offen offset:0 nt lds
    s_waitcnt vmcnt(23)
    buffer_load_dwordx4 v5, s[8:11], s40 offen offset:1024 nt lds
    s_waitcnt vmcnt(23)
    buffer_load_dwordx4 v6, s[8:11], s40 offen offset:2048 nt lds
    s_waitcnt vmcnt(23)
    buffer_load_dwordx4 v7, s[8:11], s40 offen offset:3072 nt lds
    s_add_u32 m0, m0, 4096
    s_waitcnt vmcnt(23)
    buffer_load_dwordx4 v4, s[8:11], s41 offen offset:0 nt lds
    s_waitcnt vmcnt(23)
    buffer_load_dwordx4 v5, s[8:11], s41 offen offset:1024 nt lds
    s_waitcnt vmcnt(23)
    buffer_load_dwordx4 v6, s[8:11], s41 offen offset:2048 nt lds
    s_waitcnt vmcnt(23)
    s_add_i32 s44, s38, -2
    v_mov_b32 v22, s44
    ds_write_b32 v19, v22
    buffer_load_dwordx4 v7, s[8:11], s41 offen offset:3072 nt lds
    s_mov_b32 m0, s39
    s_waitcnt vmcnt(23)
    buffer_load_dwordx4 v4, s[12:15], s31 offen offset:0 nt lds
    s_waitcnt vmcnt(23)
    buffer_load_dwordx4 v5, s[12:15], s31 offen offset:1024 nt lds
    s_waitcnt vmcnt(23)
    buffer_load_dwordx4 v6, s[12:15], s31 offen offset:2048 nt lds
    s_waitcnt vmcnt(23)
    buffer_load_dwordx4 v7, s[12:15], s31 offen offset:3072 nt lds
    s_add_u32 m0, m0, 4096
    s_waitcnt vmcnt(23)
    buffer_load_dwordx4 v4, s[12:15], s32 offen offset:0 nt lds
    s_waitcnt vmcnt(23)
    buffer_load_dwordx4 v5, s[12:15], s32 offen offset:1024 nt lds
    s_waitcnt vmcnt(23)
    buffer_load_dwordx4 v6, s[12:15], s32 offen offset:2048 nt lds
    s_waitcnt vmcnt(23)
    s_add_i32 s44, s38, -1
    v_mov_b32 v22, s44
    ds_write_b32 v19, v22
    buffer_load_dwordx4 v7, s[12:15], s32 offen offset:3072 nt lds
    s_branch L_next
.p2align 8
    s_waitcnt vmcnt(24)
    s_add_i32 s44, s38, -3
    v_mov_b32 v22, s44
    ds_write_b32 v19, v22
    buffer_load_dwordx4 v4, s[8:11], s40 offen offset:0 nt lds
    s_waitcnt vmcnt(24)
    buffer_load_dwordx4 v5, s[8:11], s40 offen offset:1024 nt lds
    s_waitcnt vmcnt(24)
    buffer_load_dwordx4 v6, s[8:11], s40 offen offset:2048 nt lds
    s_waitcnt vmcnt(24)
    buffer_load_dwordx4 v7, s[8:11], s40 offen offset:3072 nt lds
    s_add_u32 m0, m0, 4096
    s_waitcnt vmcnt(24)
    buffer_load_dwordx4 v4, s[8:11], s41 offen offset:0 nt lds
    s_waitcnt vmcnt(24)
    buffer_load_dwordx4 v5, s[8:11], s41 offen offset:1024 nt lds
    s_waitcnt vmcnt(24)
    buffer_load_dwordx4 v6, s[8:11], s41 offen offset:2048 nt lds
    s_waitcnt vmcnt(24)
    buffer_load_dwordx4 v7, s[8:11], s41 offen offset:3072 nt lds
    s_mov_b32 m0, s39
    s_waitcnt vmcnt(24)
    s_add_i32 s44, s38, -2
    v_mov_b32 v22, s44
    ds_write_b32 v19, v22
    buffer_load_dwordx4 v4, s[12:15], s31 offen offset:0 nt lds
    s_waitcnt vmcnt(24)
    buffer_load_dwordx4 v5, s[12:15], s31 offen offset:1024 nt lds
    s_waitcnt vmcnt(24)
    buffer_load_dwordx4 v6, s[12:15], s31 offen offset:2048 nt lds
    s_waitcnt vmcnt(24)
    buffer_load_dwordx4 v7, s[12:15], s31 offen offset:3072 nt lds
    s_add_u32 m0, m0, 4096
    s_waitcnt vmcnt(24)
    buffer_load_dwordx4 v4, s[12:15], s32 offen offset:0 nt lds
    s_waitcnt vmcnt(24)
    buffer_load_dwordx4 v5, s[12:15], s32 offen offset:1024 nt lds
    s_waitcnt vmcnt(24)
    buffer_load_dwordx4 v6, s[12:15], s32 offen offset:2048 nt lds
    s_waitcnt vmcnt(24)
    buffer_load_dwordx4 v7, s[12:15], s32 offen offset:3072 nt lds
    s_branch L_next
.p2align 8
    s_waitcnt vmcnt(25)
    buffer_load_dwordx4 v4, s[8:11], s40 offen offset:0 nt lds
    s_waitcnt vmcnt(25)
    s_add_i32 s44, s38, -3
    v_mov_b32 v22, s44
    ds_write_b32 v19, v22
    buffer_load_dwordx4 v5, s[8:11], s40 offen offset:1024 nt lds
    s_waitcnt vmcnt(25)
    buffer_load_dwordx4 v6, s[8:11], s40 offen offset:2048 nt lds
    s_waitcnt vmcnt(25)
    buffer_load_dwordx4 v7, s[8:11], s40 offen offset:3072 nt lds
    s_add_u32 m0, m0, 4096
    s_waitcnt vmcnt(25)
    buffer_load_dwordx4 v4, s[8:11], s41 offen offset:0 nt lds
    s_waitcnt vmcnt(25)
    buffer_load_dwordx4 v5, s[8:11], s41 offen offset:1024 nt lds
    s_waitcnt vmcnt(25)
    buffer_load_dwordx4 v6, s[8:11], s41 offen offset:2048 nt lds
    s_waitcnt vmcnt(25)
    buffer_load_dwordx4 v7, s[8:11], s41 offen offset:3072 nt lds
    s_mov_b32 m0, s39
    s_waitcnt vmcnt(25)
    buffer_load_dwordx4 v4, s[12:15], s31 offen offset:0 nt lds
    s_waitcnt vmcnt(25)
    s_add_i32 s44, s38, -2
    v_mov_b32 v22, s44
    ds_write_b32 v19, v22
    buffer_load_dwordx4 v5, s[12:15], s31 offen offset:1024 nt lds
    s_waitcnt vmcnt(25)
    buffer_load_dwordx4 v6, s[12:15], s31 offen offset:2048 nt lds
    s_waitcnt vmcnt(25)
    buffer_load_dwordx4 v7, s[12:15], s31 offen offset:3072 nt lds
    s_add_u32 m0, m0, 4096
    s_waitcnt vmcnt(25)
    buffer_load_dwordx4 v4, s[12:15], s32 offen offset:0 nt lds
    s_waitcnt vmcnt(25)
    buffer_load_dwordx4 v5, s[12:15], s32 offen offset:1024 nt lds
    s_waitcnt vmcnt(25)
    buffer_load_dwordx4 v6, s[12:15], s32 offen offset:2048 nt lds
    s_waitcnt vmcnt(25)
    buffer_load_dwordx4 v7, s[12:15], s32 offen offset:3072 nt lds
    s_branch L_next
.p2align 8
    s_waitcnt vmcnt(26)
    buffer_load_dwordx4 v4, s[8:11], s40 offen offset:0 nt lds
    s_waitcnt vmcnt(26)
    buffer_load_dwordx4 v5, s[8:11], s40 offen offset:1024 nt lds
    s_waitcnt vmcnt(26)
    s_add_i32 s44, s38, -3
    v_mov_b32 v22, s44
    ds_write_b32 v19, v22
    buffer_load_dwordx4 v6, s[8:11], s40 offen offset:2048 nt lds
    s_waitcnt vmcnt(26)
    buffer_load_dwordx4 v7, s[8:11], s40 offen offset:3072 nt lds
    s_add_u32 m0, m0, 4096
    s_waitcnt vmcnt(26)
    buffer_load_dwordx4 v4, s[8:11], s41 offen offset:0 nt lds
    s_waitcnt vmcnt(26)
    buffer_load_dwordx4 v5, s[8:11], s41 offen offset:1024 nt lds
    s_waitcnt vmcnt(26)
    buffer_load_dwordx4 v6, s[8:11], s41 offen offset:2048 nt lds
    s_waitcnt vmcnt(26)
    buffer_load_dwordx4 v7, s[8:11], s41 offen offset:3072 nt lds
    s_mov_b32 m0, s39
    s_waitcnt vmcnt(26)
    buffer_load_dwordx4 v4, s[12:15], s31 offen offset:0 nt lds
    s_waitcnt vmcnt(26)
    buffer_load_dwordx4 v5, s[12:15], s31 offen offset:1024 nt lds
    s_waitcnt vmcnt(26)
    s_add_i32 s44, s38, -2
    v_mov_b32 v22, s44
    ds_write_b32 v19, v22
    buffer_load_dwordx4 v6, s[12:15], s31 offen offset:2048 nt lds
    s_waitcnt vmcnt(26)
    buffer_load_dwordx4 v7, s[12:15], s31 offen offset:3072 nt lds
    s_add_u32 m0, m0, 4096
    s_waitcnt vmcnt(26)
    buffer_load_dwordx4 v4, s[12:15], s32 offen offset:0 nt lds
    s_waitcnt vmcnt(26)
    buffer_load_dwordx4 v5, s[12:15], s32 offen offset:1024 nt lds
    s_waitcnt vmcnt(26)
    buffer_load_dwordx4 v6, s[12:15], s32 offen offset:2048 nt lds
    s_waitcnt vmcnt(26)
    buffer_load_dwordx4 v7, s[12:15], s32 offen offset:3072 nt lds
    s_branch L_next
.p2align 8
    s_waitcnt vmcnt(27)
    buffer_load_dwordx4 v4, s[8:11], s40 offen offset:0 nt lds
    s_waitcnt vmcnt(27)
    buffer_load_dwordx4 v5, s[8:11], s40 offen offset:1024 nt lds
    s_waitcnt vmcnt(27)
    buffer_load_dwordx4 v6, s[8:11], s40 offen offset:2048 nt lds
    s_waitcnt vmcnt(27)
    s_add_i32 s44, s38, -3
    v_mov_b32 v22, s44
    ds_write_b32 v19, v22
    buffer_load_dwordx4 v7, s[8:11], s40 offen offset:3072 nt lds
    s_add_u32 m0, m0, 4096
    s_waitcnt vmcnt(27)
    buffer_load_dwordx4 v4, s[8:11], s41 offen offset:0 nt lds
    s_waitcnt vmcnt(27)
    buffer_load_dwordx4 v5, s[8:11], s41 offen offset:1024 nt lds
    s_waitcnt vmcnt(27)
    buffer_load_dwordx4 v6, s[8:11], s41 offen offset:2048 nt lds
    s_waitcnt vmcnt(27)
    buffer_load_dwordx4 v7, s[8:11], s41 offen offset:3072 nt lds
    s_mov_b32 m0, s39
    s_waitcnt vmcnt(27)
    buffer_load_dwordx4 v4, s[12:15], s31 offen offset:0 nt lds
    s_waitcnt vmcnt(27)
    buffer_load_dwordx4 v5, s[12:15], s31 offen offset:1024 nt lds
    s_waitcnt vmcnt(27)
    buffer_load_dwordx4 v6, s[12:15], s31 offen offset:2048 nt lds
    s_waitcnt vmcnt(27)
    s_add_i32 s44, s38, -2
    v_mov_b32 v22, s44
    ds_write_b32 v19, v22
    buffer_load_dwordx4 v7, s[12:15], s31 offen offset:3072 nt lds
    s_add_u32 m0, m0, 4096
    s_waitcnt vmcnt(27)
    buffer_load_dwordx4 v4, s[12:15], s32 offen offset:0 nt lds
    s_waitcnt vmcnt(27)
    buffer_load_dwordx4 v5, s[12:15], s32 offen offset:1024 nt lds
    s_waitcnt vmcnt(27)
    buffer_load_dwordx4 v6, s[12:15], s32 offen offset:2048 nt lds
    s_waitcnt vmcnt(27)
    buffer_load_dwordx4 v7, s[12:15], s32 offen offset:3072 nt lds
    s_branch L_next
.p2align 8
    s_waitcnt vmcnt(28)
    buffer_load_dwordx4 v4, s[8:11], s40 offen offset:0 nt lds
    s_waitcnt vmcnt(28)
    buffer_load_dwordx4 v5, s[8:11], s40 offen offset:1024 nt lds
    s_waitcnt vmcnt(28)
    buffer_load_dwordx4 v6, s[8:11], s40 offen offset:2048 nt lds
    s_waitcnt vmcnt(28)
    buffer_load_dwordx4 v7, s[8:11], s40 offen offset:3072 nt lds
    s_add_u32 m0, m0, 4096
    s_waitcnt vmcnt(28)
    s_add_i32 s44, s38, -3
    v_mov_b32 v22, s44
    ds_write_b32 v19, v22
    buffer_load_dwordx4 v4, s[8:11], s41 offen offset:0 nt lds
    s_waitcnt vmcnt(28)
    buffer_load_dwordx4 v5, s[8:11], s41 offen offset:1024 nt lds
    s_waitcnt vmcnt(28)
    buffer_load_dwordx4 v6, s[8:11], s41 offen offset:2048 nt lds
    s_waitcnt vmcnt(28)
    buffer_load_dwordx4 v7, s[8:11], s41 offen offset:3072 nt lds
    s_mov_b32 m0, s39
    s_waitcnt vmcnt(28)
    buffer_load_dwordx4 v4, s[12:15], s31 offen offset:0 nt lds
    s_waitcnt vmcnt(28)
    buffer_load_dwordx4 v5, s[12:15], s31 offen offset:1024 nt lds
    s_waitcnt vmcnt(28)
    buffer_load_dwordx4 v6, s[12:15], s31 offen offset:2048 nt lds
    s_waitcnt vmcnt(28)
    buffer_load_dwordx4 v7, s[12:15], s31 offen offset:3072 nt lds
    s_add_u32 m0, m0, 4096
    s_waitcnt vmcnt(28)
    s_add_i32 s44, s38, -2
    v_mov_b32 v22, s44
    ds_write_b32 v19, v22
    buffer_load_dwordx4 v4, s[12:15], s32 offen offset:0 nt lds
    s_waitcnt vmcnt(28)
    buffer_load_dwordx4 v5, s[12:15], s32 offen offset:1024 nt lds
    s_waitcnt vmcnt(28)
    buffer_load_dwordx4 v6, s[12:15], s32 offen offset:2048 nt lds
    s_waitcnt vmcnt(28)
    buffer_load_dwordx4 v7, s[12:15], s32 offen offset:3072 nt lds
    s_branch L_next
.p2align 8
    s_waitcnt vmcnt(29)
    buffer_load_dwordx4 v4, s[8:11], s40 offen offset:0 nt lds
    s_waitcnt vmcnt(29)
    buffer_load_dwordx4 v5, s[8:11], s40 offen offset:1024 nt lds
    s_waitcnt vmcnt(29)
    buffer_load_dwordx4 v6, s[8:11], s40 offen offset:2048 nt lds
    s_waitcnt vmcnt(29)
    buffer_load_dwordx4 v7, s[8:11], s40 offen offset:3072 nt lds
    s_add_u32 m0, m0, 4096
    s_waitcnt vmcnt(29)
    buffer_load_dwordx4 v4, s[8:11], s41 offen offset:0 nt lds
    s_waitcnt vmcnt(29)
    s_add_i32 s44, s38, -3
    v_mov_b32 v22, s44
    ds_write_b32 v19, v22
    buffer_load_dwordx4 v5, s[8:11], s41 offen offset:1024 nt lds
    s_waitcnt vmcnt(29)
    buffer_load_dwordx4 v6, s[8:11], s41 offen offset:2048 nt lds
    s_waitcnt vmcnt(29)
    buffer_load_dwordx4 v7, s[8:11], s41 offen offset:3072 nt lds
    s_mov_b32 m0, s39
    s_waitcnt vmcnt(29)
    buffer_load_dwordx4 v4, s[12:15], s31 offen offset:0 nt lds
    s_waitcnt vmcnt(29)
    buffer_load_dwordx4 v5, s[12:15], s31 offen offset:1024 nt lds
    s_waitcnt vmcnt(29)
    buffer_load_dwordx4 v6, s[12:15], s31 offen offset:2048 nt lds
    s_waitcnt vmcnt(29)
    buffer_load_dwordx4 v7, s[12:15], s31 offen offset:3072 nt lds
    s_add_u32 m0, m0, 4096
    s_waitcnt vmcnt(29)
    buffer_load_dwordx4 v4, s[12:15], s32 offen offset:0 nt lds
    s_waitcnt vmcnt(29)
    s_add_i32 s44, s38, -2
    v_mov_b32 v22, s44
    ds_write_b32 v19, v22
    buffer_load_dwordx4 v5, s[12:15], s32 offen offset:1024 nt lds
    s_waitcnt vmcnt(29)
    buffer_load_dwordx4 v6, s[12:15], s32 offen offset:2048 nt lds
    s_waitcnt vmcnt(29)
    buffer_load_dwordx4 v7, s[12:15], s32 offen offset:3072 nt lds
    s_branch L_next
.p2align 8
    s_waitcnt vmcnt(30)
    buffer_load_dwordx4 v4, s[8:11], s40 offen offset:0 nt lds
    s_waitcnt vmcnt(30)
    buffer_load_dwordx4 v5, s[8:11], s40 offen offset:1024 nt lds
    s_waitcnt vmcnt(30)
    buffer_load_dwordx4 v6, s[8:11], s40 offen offset:2048 nt lds
    s_waitcnt vmcnt(30)
    buffer_load_dwordx4 v7, s[8:11], s40 offen offset:3072 nt lds
    s_add_u32 m0, m0, 4096
    s_waitcnt vmcnt(30)
    buffer_load_dwordx4 v4, s[8:11], s41 offen offset:0 nt lds
    s_waitcnt vmcnt(30)
    buffer_load_dwordx4 v5, s[8:11], s41 offen offset:1024 nt lds
    s_waitcnt vmcnt(30)
    s_add_i32 s44, s38, -3
    v_mov_b32 v22, s44
    ds_write_b32 v19, v22
    buffer_load_dwordx4 v6, s[8:11], s41 offen offset:2048 nt lds
    s_waitcnt vmcnt(30)
    buffer_load_dwordx4 v7, s[8:11], s41 offen offset:3072 nt lds
    s_mov_b32 m0, s39
    s_waitcnt vmcnt(30)
    buffer_load_dwordx4 v4, s[12:15], s31 offen offset:0 nt lds
    s_waitcnt vmcnt(30)
    buffer_load_dwordx4 v5, s[12:15], s31 offen offset:1024 nt lds
    s_waitcnt vmcnt(30)
    buffer_load_dwordx4 v6, s[12:15], s31 offen offset:2048 nt lds
    s_waitcnt vmcnt(30)
    buffer_load_dwordx4 v7, s[12:15], s31 offen offset:3072 nt lds
    s_add_u32 m0, m0, 4096
    s_waitcnt vmcnt(30)
    buffer_load_dwordx4 v4, s[12:15], s32 offen offset:0 nt lds
    s_waitcnt vmcnt(30)
    buffer_load_dwordx4 v5, s[12:15], s32 offen offset:1024 nt lds
    s_waitcnt vmcnt(30)
    s_add_i32 s44, s38, -2
    v_mov_b32 v22, s44
    ds_write_b32 v19, v22
    buffer_load_dwordx4 v6, s[12:15], s32 offen offset:2048 nt lds
    s_waitcnt vmcnt(30)
    buffer_load_dwordx4 v7, s[12:15], s32 offen offset:3072 nt lds
    s_branch L_next
.p2align 8
    s_waitcnt vmcnt(31)
    buffer_load_dwordx4 v4, s[8:11], s40 offen offset:0 nt lds
    s_waitcnt vmcnt(31)
    buffer_load_dwordx4 v5, s[8:11], s40 offen offset:1024 nt lds
    s_waitcnt vmcnt(31)
    buffer_load_dwordx4 v6, s[8:11], s40 offen offset:2048 nt lds
    s_waitcnt vmcnt(31)
    buffer_load_dwordx4 v7, s[8:11], s40 offen offset:3072 nt lds
    s_add_u32 m0, m0, 4096
    s_waitcnt vmcnt(31)
    buffer_load_dwordx4 v4, s[8:11], s41 offen offset:0 nt lds
    s_waitcnt vmcnt(31)
    buffer_load_dwordx4 v5, s[8:11], s41 offen offset:1024 nt lds
    s_waitcnt vmcnt(31)
    buffer_load_dwordx4 v6, s[8:11], s41 offen offset:2048 nt lds
    s_waitcnt vmcnt(31)
    s_add_i32 s44, s38, -3
    v_mov_b32 v22, s44
    ds_write_b32 v19, v22
    buffer_load_dwordx4 v7, s[8:11], s41 offen offset:3072 nt lds
    s_mov_b32 m0, s39
    s_waitcnt vmcnt(31)
    buffer_load_dwordx4 v4, s[12:15], s31 offen offset:0 nt lds
    s_waitcnt vmcnt(31)
    buffer_load_dwordx4 v5, s[12:15], s31 offen offset:1024 nt lds
    s_waitcnt vmcnt(31)
    buffer_load_dwordx4 v6, s[12:15], s31 offen offset:2048 nt lds
    s_waitcnt vmcnt(31)
    buffer_load_dwordx4 v7, s[12:15], s31 offen offset:3072 nt lds
    s_add_u32 m0, m0, 4096
    s_waitcnt vmcnt(31)
    buffer_load_dwordx4 v4, s[12:15], s32 offen offset:0 nt lds
    s_waitcnt vmcnt(31)
    buffer_load_dwordx4 v5, s[12:15], s32 offen offset:1024 nt lds
    s_waitcnt vmcnt(31)
    buffer_load_dwordx4 v6, s[12:15], s32 offen offset:2048 nt lds
    s_waitcnt vmcnt(31)
    s_add_i32 s44, s38, -2
    v_mov_b32 v22, s44
    ds_write_b32 v19, v22
    buffer_load_dwordx4 v7, s[12:15], s32 offen offset:3072 nt lds
    s_branch L_next
.p2align 8
    s_waitcnt vmcnt(32)
    s_add_i32 s44, s38, -4
    v_mov_b32 v22, s44
    ds_write_b32 v19, v22
    buffer_load_dwordx4 v4, s[8:11], s40 offen offset:0 nt lds
    s_waitcnt vmcnt(32)
    buffer_load_dwordx4 v5, s[8:11], s40 offen offset:1024 nt lds
    s_waitcnt vmcnt(32)
    buffer_load_dwordx4 v6, s[8:11], s40 offen offset:2048 nt lds
    s_waitcnt vmcnt(32)
    buffer_load_dwordx4 v7, s[8:11], s40 offen offset:3072 nt lds
    s_add_u32 m0, m0, 4096
    s_waitcnt vmcnt(32)
    buffer_load_dwordx4 v4, s[8:11], s41 offen offset:0 nt lds
    s_waitcnt vmcnt(32)
    buffer_load_dwordx4 v5, s[8:11], s41 offen offset:1024 nt lds
    s_waitcnt vmcnt(32)
    buffer_load_dwordx4 v6, s[8:11], s41 offen offset:2048 nt lds
    s_waitcnt vmcnt(32)
    buffer_load_dwordx4 v7, s[8:11], s41 offen offset:3072 nt lds
    s_mov_b32 m0, s39
    s_waitcnt vmcnt(32)
    s_add_i32 s44, s38, -3
    v_mov_b32 v22, s44
    ds_write_b32 v19, v22
    buffer_load_dwordx4 v4, s[12:15], s31 offen offset:0 nt lds
    s_waitcnt vmcnt(32)
    buffer_load_dwordx4 v5, s[12:15], s31 offen offset:1024 nt lds
    s_waitcnt vmcnt(32)
    buffer_load_dwordx4 v6, s[12:15], s31 offen offset:2048 nt lds
    s_waitcnt vmcnt(32)
    buffer_load_dwordx4 v7, s[12:15], s31 offen offset:3072 nt lds
    s_add_u32 m0, m0, 4096
    s_waitcnt vmcnt(32)
    buffer_load_dwordx4 v4, s[12:15], s32 offen offset:0 nt lds
    s_waitcnt vmcnt(32)
    buffer_load_dwordx4 v5, s[12:15], s32 offen offset:1024 nt lds
    s_waitcnt vmcnt(32)
    buffer_load_dwordx4 v6, s[12:15], s32 offen offset:2048 nt lds
    s_waitcnt vmcnt(32)
    buffer_load_dwordx4 v7, s[12:15], s32 offen offset:3072 nt lds
    s_branch L_next
.p2align 8
    s_waitcnt vmcnt(33)
    buffer_load_dwordx4 v4, s[8:11], s40 offen offset:0 nt lds
    s_waitcnt vmcnt(33)
    s_add_i32 s44, s38, -4
    v_mov_b32 v22, s44
    ds_write_b32 v19, v22
    buffer_load_dwordx4 v5, s[8:11], s40 offen offset:1024 nt lds
    s_waitcnt vmcnt(33)
    buffer_load_dwordx4 v6, s[8:11], s40 offen offset:2048 nt lds
    s_waitcnt vmcnt(33)
    buffer_load_dwordx4 v7, s[8:11], s40 offen offset:3072 nt lds
    s_add_u32 m0, m0, 4096
    s_waitcnt vmcnt(33)
    buffer_load_dwordx4 v4, s[8:11], s41 offen offset:0 nt lds
    s_waitcnt vmcnt(33)
    buffer_load_dwordx4 v5, s[8:11], s41 offen offset:1024 nt lds
    s_waitcnt vmcnt(33)
    buffer_load_dwordx4 v6, s[8:11], s41 offen offset:2048 nt lds
    s_waitcnt vmcnt(33)
    buffer_load_dwordx4 v7, s[8:11], s41 offen offset:3072 nt lds
    s_mov_b32 m0, s39
    s_waitcnt vmcnt(33)
    buffer_load_dwordx4 v4, s[12:15], s31 offen offset:0 nt lds
    s_waitcnt vmcnt(33)
    s_add_i32 s44, s38, -3
    v_mov_b32 v22, s44
    ds_write_b32 v19, v22
    buffer_load_dwordx4 v5, s[12:15], s31 offen offset:1024 nt lds
    s_waitcnt vmcnt(33)
    buffer_load_dwordx4 v6, s[12:15], s31 offen offset:2048 nt lds
    s_waitcnt vmcnt(33)
    buffer_load_dwordx4 v7, s[12:15], s31 offen offset:3072 nt lds
    s_add_u32 m0, m0, 4096
    s_waitcnt vmcnt(33)
    buffer_load_dwordx4 v4, s[12:15], s32 offen offset:0 nt lds
    s_waitcnt vmcnt(33)
    buffer_load_dwordx4 v5, s[12:15], s32 offen offset:1024 nt lds
    s_waitcnt vmcnt(33)
    buffer_load_dwordx4 v6, s[12:15], s32 offen offset:2048 nt lds
    s_waitcnt vmcnt(33)
    buffer_load_dwordx4 v7, s[12:15], s32 offen offset:3072 nt lds
    s_branch L_next
.p2align 8
    s_waitcnt vmcnt(34)
    buffer_load_dwordx4 v4, s[8:11], s40 offen offset:0 nt lds
    s_waitcnt vmcnt(34)
    buffer_load_dwordx4 v5, s[8:11], s40 offen offset:1024 nt lds
    s_waitcnt vmcnt(34)
    s_add_i32 s44, s38, -4
    v_mov_b32 v22, s44
    ds_write_b32 v19, v22
    buffer_load_dwordx4 v6, s[8:11], s40 offen offset:2048 nt lds
    s_waitcnt vmcnt(34)
    buffer_load_dwordx4 v7, s[8:11], s40 offen offset:3072 nt lds
    s_add_u32 m0, m0, 4096
    s_waitcnt vmcnt(34)
    buffer_load_dwordx4 v4, s[8:11], s41 offen offset:0 nt lds
    s_waitcnt vmcnt(34)
    buffer_load_dwordx4 v5, s[8:11], s41 offen offset:1024 nt lds
    s_waitcnt vmcnt(34)
    buffer_load_dwordx4 v6, s[8:11], s41 offen offset:2048 nt lds
    s_waitcnt vmcnt(34)
    buffer_load_dwordx4 v7, s[8:11], s41 offen offset:3072 nt lds
    s_mov_b32 m0, s39
    s_waitcnt vmcnt(34)
    buffer_load_dwordx4 v4, s[12:15], s31 offen offset:0 nt lds
    s_waitcnt vmcnt(34)
    buffer_load_dwordx4 v5, s[12:15], s31 offen offset:1024 nt lds
    s_waitcnt vmcnt(34)
    s_add_i32 s44, s38, -3
    v_mov_b32 v22, s44
    ds_write_b32 v19, v22
    buffer_load_dwordx4 v6, s[12:15], s31 offen offset:2048 nt lds
    s_waitcnt vmcnt(34)
    buffer_load_dwordx4 v7, s[12:15], s31 offen offset:3072 nt lds
    s_add_u32 m0, m0, 4096
    s_waitcnt vmcnt(34)
    buffer_load_dwordx4 v4, s[12:15], s32 offen offset:0 nt lds
    s_waitcnt vmcnt(34)
    buffer_load_dwordx4 v5, s[12:15], s32 offen offset:1024 nt lds
    s_waitcnt vmcnt(34)
    buffer_load_dwordx4 v6, s[12:15], s32 offen offset:2048 nt lds
    s_waitcnt vmcnt(34)
    buffer_load_dwordx4 v7, s[12:15], s32 offen offset:3072 nt lds
    s_branch L_next
.p2align 8
    s_waitcnt vmcnt(35)
    buffer_load_dwordx4 v4, s[8:11], s40 offen offset:0 nt lds
    s_waitcnt vmcnt(35)
    buffer_load_dwordx4 v5, s[8:11], s40 offen offset:1024 nt lds
    s_waitcnt vmcnt(35)
    buffer_load_dwordx4 v6, s[8:11], s40 offen offset:2048 nt lds
    s_waitcnt vmcnt(35)
    s_add_i32 s44, s38, -4
    v_mov_b32 v22, s44
    ds_write_b32 v19, v22
    buffer_load_dwordx4 v7, s[8:11], s40 offen offset:3072 nt lds
    s_add_u32 m0, m0, 4096
    s_waitcnt vmcnt(35)
    buffer_load_dwordx4 v4, s[8:11], s41 offen offset:0 nt lds
    s_waitcnt vmcnt(35)
    buffer_load_dwordx4 v5, s[8:11], s41 offen offset:1024 nt lds
    s_waitcnt vmcnt(35)
    buffer_load_dwordx4 v6, s[8:11], s41 offen offset:2048 nt lds
    s_waitcnt vmcnt(35)
    buffer_load_dwordx4 v7, s[8:11], s41 offen offset:3072 nt lds
    s_mov_b32 m0, s39
    s_waitcnt vmcnt(35)
    buffer_load_dwordx4 v4, s[12:15], s31 offen offset:0 nt lds
    s_waitcnt vmcnt(35)
    buffer_load_dwordx4 v5, s[12:15], s31 offen offset:1024 nt lds
    s_waitcnt vmcnt(35)
    buffer_load_dwordx4 v6, s[12:15], s31 offen offset:2048 nt lds
    s_waitcnt vmcnt(35)
    s_add_i32 s44, s38, -3
    v_mov_b32 v22, s44
    ds_write_b32 v19, v22
    buffer_load_dwordx4 v7, s[12:15], s31 offen offset:3072 nt lds
    s_add_u32 m0, m0, 4096
    s_waitcnt vmcnt(35)
    buffer_load_dwordx4 v4, s[12:15], s32 offen offset:0 nt lds
    s_waitcnt vmcnt(35)
    buffer_load_dwordx4 v5, s[12:15], s32 offen offset:1024 nt lds
    s_waitcnt vmcnt(35)
    buffer_load_dwordx4 v6, s[12:15], s32 offen offset:2048 nt lds
    s_waitcnt vmcnt(35)
    buffer_load_dwordx4 v7, s[12:15], s32 offen offset:3072 nt lds
    s_branch L_next
.p2align 8
    s_waitcnt vmcnt(36)
    buffer_load_dwordx4 v4, s[8:11], s40 offen offset:0 nt lds
    s_waitcnt vmcnt(36)
    buffer_load_dwordx4 v5, s[8:11], s40 offen offset:1024 nt lds
    s_waitcnt vmcnt(36)
    buffer_load_dwordx4 v6, s[8:11], s40 offen offset:2048 nt lds
    s_waitcnt vmcnt(36)
    buffer_load_dwordx4 v7, s[8:11], s40 offen offset:3072 nt lds
    s_add_u32 m0, m0, 4096
    s_waitcnt vmcnt(36)
    s_add_i32 s44, s38, -4
    v_mov_b32 v22, s44
    ds_write_b32 v19, v22
    buffer_load_dwordx4 v4, s[8:11], s41 offen offset:0 nt lds
    s_waitcnt vmcnt(36)
    buffer_load_dwordx4 v5, s[8:11], s41 offen offset:1024 nt lds
    s_waitcnt vmcnt(36)
    buffer_load_dwordx4 v6, s[8:11], s41 offen offset:2048 nt lds
    s_waitcnt vmcnt(36)
    buffer_load_dwordx4 v7, s[8:11], s41 offen offset:3072 nt lds
    s_mov_b32 m0, s39
    s_waitcnt vmcnt(36)
    buffer_load_dwordx4 v4, s[12:15], s31 offen offset:0 nt lds
    s_waitcnt vmcnt(36)
    buffer_load_dwordx4 v5, s[12:15], s31 offen offset:1024 nt lds
    s_waitcnt vmcnt(36)
    buffer_load_dwordx4 v6, s[12:15], s31 offen offset:2048 nt lds
    s_waitcnt vmcnt(36)
    buffer_load_dwordx4 v7, s[12:15], s31 offen offset:3072 nt lds
    s_add_u32 m0, m0, 4096
    s_waitcnt vmcnt(36)
    s_add_i32 s44, s38, -3
    v_mov_b32 v22, s44
    ds_write_b32 v19, v22
    buffer_load_dwordx4 v4, s[12:15], s32 offen offset:0 nt lds
    s_waitcnt vmcnt(36)
    buffer_load_dwordx4 v5, s[12:15], s32 offen offset:1024 nt lds
    s_waitcnt vmcnt(36)
    buffer_load_dwordx4 v6, s[12:15], s32 offen offset:2048 nt lds
    s_waitcnt vmcnt(36)
    buffer_load_dwordx4 v7, s[12:15], s32 offen offset:3072 nt lds
    s_branch L_next
.p2align 8
    s_waitcnt vmcnt(37)
    buffer_load_dwordx4 v4, s[8:11], s40 offen offset:0 nt lds
    s_waitcnt vmcnt(37)
    buffer_load_dwordx4 v5, s[8:11], s40 offen offset:1024 nt lds
    s_waitcnt vmcnt(37)
    buffer_load_dwordx4 v6, s[8:11], s40 offen offset:2048 nt lds
    s_waitcnt vmcnt(37)
    buffer_load_dwordx4 v7, s[8:11], s40 offen offset:3072 nt lds
    s_add_u32 m0, m0, 4096
    s_waitcnt vmcnt(37)
    buffer_load_dwordx4 v4, s[8:11], s41 offen offset:0 nt lds
    s_waitcnt vmcnt(37)
    s_add_i32 s44, s38, -4
    v_mov_b32 v22, s44
    ds_write_b32 v19, v22
    buffer_load_dwordx4 v5, s[8:11], s41 offen offset:1024 nt lds
    s_waitcnt vmcnt(37)
    buffer_load_dwordx4 v6, s[8:11], s41 offen offset:2048 nt lds
    s_waitcnt vmcnt(37)
    buffer_load_dwordx4 v7, s[8:11], s41 offen offset:3072 nt lds
    s_mov_b32 m0, s39
    s_waitcnt vmcnt(37)
    buffer_load_dwordx4 v4, s[12:15], s31 offen offset:0 nt lds
    s_waitcnt vmcnt(37)
    buffer_load_dwordx4 v5, s[12:15], s31 offen offset:1024 nt lds
    s_waitcnt vmcnt(37)
    buffer_load_dwordx4 v6, s[12:15], s31 offen offset:2048 nt lds
    s_waitcnt vmcnt(37)
    buffer_load_dwordx4 v7, s[12:15], s31 offen offset:3072 nt lds
    s_add_u32 m0, m0, 4096
    s_waitcnt vmcnt(37)
    buffer_load_dwordx4 v4, s[12:15], s32 offen offset:0 nt lds
    s_waitcnt vmcnt(37)
    s_add_i32 s44, s38, -3
    v_mov_b32 v22, s44
    ds_write_b32 v19, v22
    buffer_load_dwordx4 v5, s[12:15], s32 offen offset:1024 nt lds
    s_waitcnt vmcnt(37)
    buffer_load_dwordx4 v6, s[12:15], s32 offen offset:2048 nt lds
    s_waitcnt vmcnt(37)
    buffer_load_dwordx4 v7, s[12:15], s32 offen offset:3072 nt lds
    s_branch L_next
.p2align 8
    s_waitcnt vmcnt(38)
    buffer_load_dwordx4 v4, s[8:11], s40 offen offset:0 nt lds
    s_waitcnt vmcnt(38)
    buffer_load_dwordx4 v5, s[8:11], s40 offen offset:1024 nt lds
    s_waitcnt vmcnt(38)
    buffer_load_dwordx4 v6, s[8:11], s40 offen offset:2048 nt lds
    s_waitcnt vmcnt(38)
    buffer_load_dwordx4 v7, s[8:11], s40 offen offset:3072 nt lds
    s_add_u32 m0, m0, 4096
    s_waitcnt vmcnt(38)
    buffer_load_dwordx4 v4, s[8:11], s41 offen offset:0 nt lds
    s_waitcnt vmcnt(38)
    buffer_load_dwordx4 v5, s[8:11], s41 offen offset:1024 nt lds
    s_waitcnt vmcnt(38)
    s_add_i32 s44, s38, -4
    v_mov_b32 v22, s44
    ds_write_b32 v19, v22
    buffer_load_dwordx4 v6, s[8:11], s41 offen offset:2048 nt lds
    s_waitcnt vmcnt(38)
    buffer_load_dwordx4 v7, s[8:11], s41 offen offset:3072 nt lds
    s_mov_b32 m0, s39
    s_waitcnt vmcnt(38)
    buffer_load_dwordx4 v4, s[12:15], s31 offen offset:0 nt lds
    s_waitcnt vmcnt(38)
    buffer_load_dwordx4 v5, s[12:15], s31 offen offset:1024 nt lds
    s_waitcnt vmcnt(38)
    buffer_load_dwordx4 v6, s[12:15], s31 offen offset:2048 nt lds
    s_waitcnt vmcnt(38)
    buffer_load_dwordx4 v7, s[12:15], s31 offen offset:3072 nt lds
    s_add_u32 m0, m0, 4096
    s_waitcnt vmcnt(38)
    buffer_load_dwordx4 v4, s[12:15], s32 offen offset:0 nt lds
    s_waitcnt vmcnt(38)
    buffer_load_dwordx4 v5, s[12:15], s32 offen offset:1024 nt lds
    s_waitcnt vmcnt(38)
    s_add_i32 s44, s38, -3
    v_mov_b32 v22, s44
    ds_write_b32 v19, v22
    buffer_load_dwordx4 v6, s[12:15], s32 offen offset:2048 nt lds
    s_waitcnt vmcnt(38)
    buffer_load_dwordx4 v7, s[12:15], s32 offen offset:3072 nt lds
    s_branch L_next
.p2align 8
    s_waitcnt vmcnt(39)
    buffer_load_dwordx4 v4, s[8:11], s40 offen offset:0 nt lds
    s_waitcnt vmcnt(39)
    buffer_load_dwordx4 v5, s[8:11], s40 offen offset:1024 nt lds
    s_waitcnt vmcnt(39)
    buffer_load_dwordx4 v6, s[8:11], s40 offen offset:2048 nt lds
    s_waitcnt vmcnt(39)
    buffer_load_dwordx4 v7, s[8:11], s40 offen offset:3072 nt lds
    s_add_u32 m0, m0, 4096
    s_waitcnt vmcnt(39)
    buffer_load_dwordx4 v4, s[8:11], s41 offen offset:0 nt lds
    s_waitcnt vmcnt(39)
    buffer_load_dwordx4 v5, s[8:11], s41 offen offset:1024 nt lds
    s_waitcnt vmcnt(39)
    buffer_load_dwordx4 v6, s[8:11], s41 offen offset:2048 nt lds
    s_waitcnt vmcnt(39)
    s_add_i32 s44, s38, -4
    v_mov_b32 v22, s44
    ds_write_b32 v19, v22
    buffer_load_dwordx4 v7, s[8:11], s41 offen offset:3072 nt lds
    s_mov_b32 m0, s39
    s_waitcnt vmcnt(39)
    buffer_load_dwordx4 v4, s[12:15], s31 offen offset:0 nt lds
    s_waitcnt vmcnt(39)
    buffer_load_dwordx4 v5, s[12:15], s31 offen offset:1024 nt lds
    s_waitcnt vmcnt(39)
    buffer_load_dwordx4 v6, s[12:15], s31 offen offset:2048 nt lds
    s_waitcnt vmcnt(39)
    buffer_load_dwordx4 v7, s[12:15], s31 offen offset:3072 nt lds
    s_add_u32 m0, m0, 4096
    s_waitcnt vmcnt(39)
    buffer_load_dwordx4 v4, s[12:15], s32 offen offset:0 nt lds
    s_waitcnt vmcnt(39)
    buffer_load_dwordx4 v5, s[12:15], s32 offen offset:1024 nt lds
    s_waitcnt vmcnt(39)
    buffer_load_dwordx4 v6, s[12:15], s32 offen offset:2048 nt lds
    s_waitcnt vmcnt(39)
    s_add_i32 s44, s38, -3
    v_mov_b32 v22, s44
    ds_write_b32 v19, v22
    buffer_load_dwordx4 v7, s[12:15], s32 offen offset:3072 nt lds
    s_branch L_next
.p2align 8
    s_waitcnt vmcnt(7)
    buffer_load_dwordx4 v4, s[8:11], s40 offen offset:0  lds
    s_waitcnt vmcnt(7)
    buffer_load_dwordx4 v5, s[8:11], s40 offen offset:1024  lds
    s_waitcnt vmcnt(7)
    buffer_load_dwordx4 v6, s[8:11], s40 offen offset:2048  lds
    s_waitcnt vmcnt(7)
    buffer_load_dwordx4 v7, s[8:11], s40 offen offset:3072  lds
    s_add_u32 m0, m0, 4096
    s_waitcnt vmcnt(7)
    buffer_load_dwordx4 v4, s[8:11], s41 offen offset:0  lds
    s_waitcnt vmcnt(7)
    buffer_load_dwordx4 v5, s[8:11], s41 offen offset:1024  lds
    s_waitcnt vmcnt(7)
    buffer_load_dwordx4 v6, s[8:11], s41 offen offset:2048  lds
    s_waitcnt vmcnt(7)
    s_add_i32 s44, s38, 0
    v_mov_b32 v22, s44
    ds_write_b32 v19, v22
    buffer_load_dwordx4 v7, s[8:11], s41 offen offset:3072  lds
    s_mov_b32 m0, s39
    s_waitcnt vmcnt(7)
    buffer_load_dwordx4 v4, s[12:15], s31 offen offset:0  lds
    s_waitcnt vmcnt(7)
    buffer_load_dwordx4 v5, s[12:15], s31 offen offset:1024  lds
    s_waitcnt vmcnt(7)
    buffer_load_dwordx4 v6, s[12:15], s31 offen offset:2048  lds
    s_waitcnt vmcnt(7)
    buffer_load_dwordx4 v7, s[12:15], s31 offen offset:3072  lds
    s_add_u32 m0, m0, 4096
    s_waitcnt vmcnt(7)
    buffer_load_dwordx4 v4, s[12:15], s32 offen offset:0  lds
    s_waitcnt vmcnt(7)
    buffer_load_dwordx4 v5, s[12:15], s32 offen offset:1024  lds
    s_waitcnt vmcnt(7)
    buffer_load_dwordx4 v6, s[12:15], s32 offen offset:2048  lds
    s_waitcnt vmcnt(7)
    s_add_i32 s44, s38, 1
    v_mov_b32 v22, s44
    ds_write_b32 v19, v22
    buffer_load_dwordx4 v7, s[12:15], s32 offen offset:3072  lds
    s_branch L_next
.p2align 8
    s_waitcnt vmcnt(8)
    s_add_i32 s44, s38, -1
    v_mov_b32 v22, s44
    ds_write_b32 v19, v22
    buffer_load_dwordx4 v4, s[8:11], s40 offen offset:0  lds
    s_waitcnt vmcnt(8)
    buffer_load_dwordx4 v5, s[8:11], s40 offen offset:1024  lds
    s_waitcnt vmcnt(8)
    buffer_load_dwordx4 v6, s[8:11], s40 offen offset:2048  lds
    s_waitcnt vmcnt(8)
    buffer_load_dwordx4 v7, s[8:11], s40 offen offset:3072  lds
    s_add_u32 m0, m0, 4096
    s_waitcnt vmcnt(8)
    buffer_load_dwordx4 v4, s[8:11], s41 offen offset:0  lds
    s_waitcnt vmcnt(8)
    buffer_load_dwordx4 v5, s[8:11], s41 offen offset:1024  lds
    s_waitcnt vmcnt(8)
    buffer_load_dwordx4 v6, s[8:11], s41 offen offset:2048  lds
    s_waitcnt vmcnt(8)
    buffer_load_dwordx4 v7, s[8:11], s41 offen offset:3072  lds
    s_mov_b32 m0, s39
    s_waitcnt vmcnt(8)
    s_add_i32 s44, s38, 0
    v_mov_b32 v22, s44
    ds_write_b32 v19, v22
    buffer_load_dwordx4 v4, s[12:15], s31 offen offset:0  lds
    s_waitcnt vmcnt(8)
    buffer_load_dwordx4 v5, s[12:15], s31 offen offset:1024  lds
    s_waitcnt vmcnt(8)
    buffer_load_dwordx4 v6, s[12:15], s31 offen offset:2048  lds
    s_waitcnt vmcnt(8)
    buffer_load_dwordx4 v7, s[12:15], s31 offen offset:3072  lds
    s_add_u32 m0, m0, 4096
    s_waitcnt vmcnt(8)
    buffer_load_dwordx4 v4, s[12:15], s32 offen offset:0  lds
    s_waitcnt vmcnt(8)
    buffer_load_dwordx4 v5, s[12:15], s32 offen offset:1024  lds
    s_waitcnt vmcnt(8)
    buffer_load_dwordx4 v6, s[12:15], s32 offen offset:2048  lds
    s_waitcnt vmcnt(8)
    buffer_load_dwordx4 v7, s[12:15], s32 offen offset:3072  lds
    s_branch L_next
.p2align 8
    s_waitcnt vmcnt(9)
    buffer_load_dwordx4 v4, s[8:11], s40 offen offset:0  lds
    s_waitcnt vmcnt(9)
    s_add_i32 s44, s38, -1
    v_mov_b32 v22, s44
    ds_write_b32 v19, v22
    buffer_load_dwordx4 v5, s[8:11], s40 offen offset:1024  lds
    s_waitcnt vmcnt(9)
    buffer_load_dwordx4 v6, s[8:11], s40 offen offset:2048  lds
    s_waitcnt vmcnt(9)
    buffer_load_dwordx4 v7, s[8:11], s40 offen offset:3072  lds
    s_add_u32 m0, m0, 4096
    s_waitcnt vmcnt(9)
    buffer_load_dwordx4 v4, s[8:11], s41 offen offset:0  lds
    s_waitcnt vmcnt(9)
    buffer_load_dwordx4 v5, s[8:11], s41 offen offset:1024  lds
    s_waitcnt vmcnt(9)
    buffer_load_dwordx4 v6, s[8:11], s41 offen offset:2048  lds
    s_waitcnt vmcnt(9)
    buffer_load_dwordx4 v7, s[8:11], s41 offen offset:3072  lds
    s_mov_b32 m0, s39
    s_waitcnt vmcnt(9)
    buffer_load_dwordx4 v4, s[12:15], s31 offen offset:0  lds
    s_waitcnt vmcnt(9)
    s_add_i32 s44, s38, 0
    v_mov_b32 v22, s44
    ds_write_b32 v19, v22
    buffer_load_dwordx4 v5, s[12:15], s31 offen offset:1024  lds
    s_waitcnt vmcnt(9)
    buffer_load_dwordx4 v6, s[12:15], s31 offen offset:2048  lds
    s_waitcnt vmcnt(9)
    buffer_load_dwordx4 v7, s[12:15], s31 offen offset:3072  lds
    s_add_u32 m0, m0, 4096
    s_waitcnt vmcnt(9)
    buffer_load_dwordx4 v4, s[12:15], s32 offen offset:0  lds
    s_waitcnt vmcnt(9)
    buffer_load_dwordx4 v5, s[12:15], s32 offen offset:1024  lds
    s_waitcnt vmcnt(9)
    buffer_load_dwordx4 v6, s[12:15], s32 offen offset:2048  lds
    s_waitcnt vmcnt(9)
    buffer_load_dwordx4 v7, s[12:15], s32 offen offset:3072  lds
    s_branch L_next
.p2align 8
    s_waitcnt vmcnt(10)
    buffer_load_dwordx4 v4, s[8:11], s40 offen offset:0  lds
    s_waitcnt vmcnt(10)
    buffer_load_dwordx4 v5, s[8:11], s40 offen offset:1024  lds
    s_waitcnt vmcnt(10)
    s_add_i32 s44, s38, -1
    v_mov_b32 v22, s44
    ds_write_b32 v19, v22
    buffer_load_dwordx4 v6, s[8:11], s40 offen offset:2048  lds
    s_waitcnt vmcnt(10)
    buffer_load_dwordx4 v7, s[8:11], s40 offen offset:3072  lds
    s_add_u32 m0, m0, 4096
    s_waitcnt vmcnt(10)
    buffer_load_dwordx4 v4, s[8:11], s41 offen offset:0  lds
    s_waitcnt vmcnt(10)
    buffer_load_dwordx4 v5, s[8:11], s41 offen offset:1024  lds
    s_waitcnt vmcnt(10)
    buffer_load_dwordx4 v6, s[8:11], s41 offen offset:2048  lds
    s_waitcnt vmcnt(10)
    buffer_load_dwordx4 v7, s[8:11], s41 offen offset:3072  lds
    s_mov_b32 m0, s39
    s_waitcnt vmcnt(10)
    buffer_load_dwordx4 v4, s[12:15], s31 offen offset:0  lds
    s_waitcnt vmcnt(10)
    buffer_load_dwordx4 v5, s[12:15], s31 offen offset:1024  lds
    s_waitcnt vmcnt(10)
    s_add_i32 s44, s38, 0
    v_mov_b32 v22, s44
    ds_write_b32 v19, v22
    buffer_load_dwordx4 v6, s[12:15], s31 offen offset:2048  lds
    s_waitcnt vmcnt(10)
    buffer_load_dwordx4 v7, s[12:15], s31 offen offset:3072  lds
    s_add_u32 m0, m0, 4096
    s_waitcnt vmcnt(10)
    buffer_load_dwordx4 v4, s[12:15], s32 offen offset:0  lds
    s_waitcnt vmcnt(10)
    buffer_load_dwordx4 v5, s[12:15], s32 offen offset:1024  lds
    s_waitcnt vmcnt(10)
    buffer_load_dwordx4 v6, s[12:15], s32 offen offset:2048  lds
    s_waitcnt vmcnt(10)
    buffer_load_dwordx4 v7, s[12:15], s32 offen offset:3072  lds
    s_branch L_next
.p2align 8
    s_waitcnt vmcnt(11)
    buffer_load_dwordx4 v4, s[8:11], s40 offen offset:0  lds
    s_waitcnt vmcnt(11)
    buffer_load_dwordx4 v5, s[8:11], s40 offen offset:1024  lds
    s_waitcnt vmcnt(11)
    buffer_load_dwordx4 v6, s[8:11], s40 offen offset:2048  lds
    s_waitcnt vmcnt(11)
    s_add_i32 s44, s38, -1
    v_mov_b32 v22, s44
    ds_write_b32 v19, v22
    buffer_load_dwordx4 v7, s[8:11], s40 offen offset:3072  lds
    s_add_u32 m0, m0, 4096
    s_waitcnt vmcnt(11)
    buffer_load_dwordx4 v4, s[8:11], s41 offen offset:0  lds
    s_waitcnt vmcnt(11)
    buffer_load_dwordx4 v5, s[8:11], s41 offen offset:1024  lds
    s_waitcnt vmcnt(11)
    buffer_load_dwordx4 v6, s[8:11], s41 offen offset:2048  lds
    s_waitcnt vmcnt(11)
    buffer_load_dwordx4 v7, s[8:11], s41 offen offset:3072  lds
    s_mov_b32 m0, s39
    s_waitcnt vmcnt(11)
    buffer_load_dwordx4 v4, s[12:15], s31 offen offset:0  lds
    s_waitcnt vmcnt(11)
    buffer_load_dwordx4 v5, s[12:15], s31 offen offset:1024  lds
    s_waitcnt vmcnt(11)
    buffer_load_dwordx4 v6, s[12:15], s31 offen offset:2048  lds
    s_waitcnt vmcnt(11)
    s_add_i32 s44, s38, 0
    v_mov_b32 v22, s44
    ds_write_b32 v19, v22
    buffer_load_dwordx4 v7, s[12:15], s31 offen offset:3072  lds
    s_add_u32 m0, m0, 4096
    s_waitcnt vmcnt(11)
    buffer_load_dwordx4 v4, s[12:15], s32 offen offset:0  lds
    s_waitcnt vmcnt(11)
    buffer_load_dwordx4 v5, s[12:15], s32 offen offset:1024  lds
    s_waitcnt vmcnt(11)
    buffer_load_dwordx4 v6, s[12:15], s32 offen offset:2048  lds
    s_waitcnt vmcnt(11)
    buffer_load_dwordx4 v7, s[12:15], s32 offen offset:3072  lds
    s_branch L_next
.p2align 8
    s_waitcnt vmcnt(12)
    buffer_load_dwordx4 v4, s[8:11], s40 offen offset:0  lds
    s_waitcnt vmcnt(12)
    buffer_load_dwordx4 v5, s[8:11], s40 offen offset:1024  lds
    s_waitcnt vmcnt(12)
    buffer_load_dwordx4 v6, s[8:11], s40 offen offset:2048  lds
    s_waitcnt vmcnt(12)
    buffer_load_dwordx4 v7, s[8:11], s40 offen offset:3072  lds
    s_add_u32 m0, m0, 4096
    s_waitcnt vmcnt(12)
    s_add_i32 s44, s38, -1
    v_mov_b32 v22, s44
    ds_write_b32 v19, v22
    buffer_load_dwordx4 v4, s[8:11], s41 offen offset:0  lds
    s_waitcnt vmcnt(12)
    buffer_load_dwordx4 v5, s[8:11], s41 offen offset:1024  lds
    s_waitcnt vmcnt(12)
    buffer_load_dwordx4 v6, s[8:11], s41 offen offset:2048  lds
    s_waitcnt vmcnt(12)
    buffer_load_dwordx4 v7, s[8:11], s41 offen offset:3072  lds
    s_mov_b32 m0, s39
    s_waitcnt vmcnt(12)
    buffer_load_dwordx4 v4, s[12:15], s31 offen offset:0  lds
    s_waitcnt vmcnt(12)
    buffer_load_dwordx4 v5, s[12:15], s31 offen offset:1024  lds
    s_waitcnt vmcnt(12)
    buffer_load_dwordx4 v6, s[12:15], s31 offen offset:2048  lds
    s_waitcnt vmcnt(12)
    buffer_load_dwordx4 v7, s[12:15], s31 offen offset:3072  lds
    s_add_u32 m0, m0, 4096
    s_waitcnt vmcnt(12)
    s_add_i32 s44, s38, 0
    v_mov_b32 v22, s44
    ds_write_b32 v19, v22
    buffer_load_dwordx4 v4, s[12:15], s32 offen offset:0  lds
    s_waitcnt vmcnt(12)
    buffer_load_dwordx4 v5, s[12:15], s32 offen offset:1024  lds
    s_waitcnt vmcnt(12)
    buffer_load_dwordx4 v6, s[12:15], s32 offen offset:2048  lds
    s_waitcnt vmcnt(12)
    buffer_load_dwordx4 v7, s[12:15], s32 offen offset:3072  lds
    s_branch L_next
.p2align 8
    s_waitcnt vmcnt(13)
    buffer_load_dwordx4 v4, s[8:11], s40 offen offset:0  lds
    s_waitcnt vmcnt(13)
    buffer_load_dwordx4 v5, s[8:11], s40 offen offset:1024  lds
    s_waitcnt vmcnt(13)
    buffer_load_dwordx4 v6, s[8:11], s40 offen offset:2048  lds
    s_waitcnt vmcnt(13)
    buffer_load_dwordx4 v7, s[8:11], s40 offen offset:3072  lds
    s_add_u32 m0, m0, 4096
    s_waitcnt vmcnt(13)
    buffer_load_dwordx4 v4, s[8:11], s41 offen offset:0  lds
    s_waitcnt vmcnt(13)
    s_add_i32 s44, s38, -1
    v_mov_b32 v22, s44
    ds_write_b32 v19, v22
    buffer_load_dwordx4 v5, s[8:11], s41 offen offset:1024  lds
    s_waitcnt vmcnt(13)
    buffer_load_dwordx4 v6, s[8:11], s41 offen offset:2048  lds
    s_waitcnt vmcnt(13)
    buffer_load_dwordx4 v7, s[8:11], s41 offen offset:3072  lds
    s_mov_b32 m0, s39
    s_waitcnt vmcnt(13)
    buffer_load_dwordx4 v4, s[12:15], s31 offen offset:0  lds
    s_waitcnt vmcnt(13)
    buffer_load_dwordx4 v5, s[12:15], s31 offen offset:1024  lds
    s_waitcnt vmcnt(13)
    buffer_load_dwordx4 v6, s[12:15], s31 offen offset:2048  lds
    s_waitcnt vmcnt(13)
    buffer_load_dwordx4 v7, s[12:15], s31 offen offset:3072  lds
    s_add_u32 m0, m0, 4096
    s_waitcnt vmcnt(13)
    buffer_load_dwordx4 v4, s[12:15], s32 offen offset:0  lds
    s_waitcnt vmcnt(13)
    s_add_i32 s44, s38, 0
    v_mov_b32 v22, s44
    ds_write_b32 v19, v22
    buffer_load_dwordx4 v5, s[12:15], s32 offen offset:1024  lds
    s_waitcnt vmcnt(13)
    buffer_load_dwordx4 v6, s[12:15], s32 offen offset:2048  lds
    s_waitcnt vmcnt(13)
    buffer_load_dwordx4 v7, s[12:15], s32 offen offset:3072  lds
    s_branch L_next
.p2align 8
    s_waitcnt vmcnt(14)
    buffer_load_dwordx4 v4, s[8:11], s40 offen offset:0  lds
    s_waitcnt vmcnt(14)
    buffer_load_dwordx4 v5, s[8:11], s40 offen offset:1024  lds
    s_waitcnt vmcnt(14)
    buffer_load_dwordx4 v6, s[8:11], s40 offen offset:2048  lds
    s_waitcnt vmcnt(14)
    buffer_load_dwordx4 v7, s[8:11], s40 offen offset:3072  lds
    s_add_u32 m0, m0, 4096
    s_waitcnt vmcnt(14)
    buffer_load_dwordx4 v4, s[8:11], s41 offen offset:0  lds
    s_waitcnt vmcnt(14)
    buffer_load_dwordx4 v5, s[8:11], s41 offen offset:1024  lds
    s_waitcnt vmcnt(14)
    s_add_i32 s44, s38, -1
    v_mov_b32 v22, s44
    ds_write_b32 v19, v22
    buffer_load_dwordx4 v6, s[8:11], s41 offen offset:2048  lds
    s_waitcnt vmcnt(14)
    buffer_load_dwordx4 v7, s[8:11], s41 offen offset:3072  lds
    s_mov_b32 m0, s39
    s_waitcnt vmcnt(14)
    buffer_load_dwordx4 v4, s[12:15], s31 offen offset:0  lds
    s_waitcnt vmcnt(14)
    buffer_load_dwordx4 v5, s[12:15], s31 offen offset:1024  lds
    s_waitcnt vmcnt(14)
    buffer_load_dwordx4 v6, s[12:15], s31 offen offset:2048  lds
    s_waitcnt vmcnt(14)
    buffer_load_dwordx4 v7, s[12:15], s31 offen offset:3072  lds
    s_add_u32 m0, m0, 4096
    s_waitcnt vmcnt(14)
    buffer_load_dwordx4 v4, s[12:15], s32 offen offset:0  lds
    s_waitcnt vmcnt(14)
    buffer_load_dwordx4 v5, s[12:15], s32 offen offset:1024  lds
    s_waitcnt vmcnt(14)
    s_add_i32 s44, s38, 0
    v_mov_b32 v22, s44
    ds_write_b32 v19, v22
    buffer_load_dwordx4 v6, s[12:15], s32 offen offset:2048  lds
    s_waitcnt vmcnt(14)
    buffer_load_dwordx4 v7, s[12:15], s32 offen offset:3072  lds
    s_branch L_next
.p2align 8
    s_waitcnt vmcnt(15)
    buffer_load_dwordx4 v4, s[8:11], s40 offen offset:0  lds
    s_waitcnt vmcnt(15)
    buffer_load_dwordx4 v5, s[8:11], s40 offen offset:1024  lds
    s_waitcnt vmcnt(15)
    buffer_load_dwordx4 v6, s[8:11], s40 offen offset:2048  lds
    s_waitcnt vmcnt(15)
    buffer_load_dwordx4 v7, s[8:11], s40 offen offset:3072  lds
    s_add_u32 m0, m0, 4096
    s_waitcnt vmcnt(15)
    buffer_load_dwordx4 v4, s[8:11], s41 offen offset:0  lds
    s_waitcnt vmcnt(15)
    buffer_load_dwordx4 v5, s[8:11], s41 offen offset:1024  lds
    s_waitcnt vmcnt(15)
    buffer_load_dwordx4 v6, s[8:11], s41 offen offset:2048  lds
    s_waitcnt vmcnt(15)
    s_add_i32 s44, s38, -1
    v_mov_b32 v22, s44
    ds_write_b32 v19, v22
    buffer_load_dwordx4 v7, s[8:11], s41 offen offset:3072  lds
    s_mov_b32 m0, s39
    s_waitcnt vmcnt(15)
    buffer_load_dwordx4 v4, s[12:15], s31 offen offset:0  lds
    s_waitcnt vmcnt(15)
    buffer_load_dwordx4 v5, s[12:15], s31 offen offset:1024  lds
    s_waitcnt vmcnt(15)
    buffer_load_dwordx4 v6, s[12:15], s31 offen offset:2048  lds
    s_waitcnt vmcnt(15)
    buffer_load_dwordx4 v7, s[12:15], s31 offen offset:3072  lds
    s_add_u32 m0, m0, 4096
    s_waitcnt vmcnt(15)
    buffer_load_dwordx4 v4, s[12:15], s32 offen offset:0  lds
    s_waitcnt vmcnt(15)
    buffer_load_dwordx4 v5, s[12:15], s32 offen offset:1024  lds
    s_waitcnt vmcnt(15)
    buffer_load_dwordx4 v6, s[12:15], s32 offen offset:2048  lds
    s_waitcnt vmcnt(15)
    s_add_i32 s44, s38, 0
    v_mov_b32 v22, s44
    ds_write_b32 v19, v22
    buffer_load_dwordx4 v7, s[12:15], s32 offen offset:3072  lds
    s_branch L_next
.p2align 8
    s_waitcnt vmcnt(16)
    s_add_i32 s44, s38, -2
    v_mov_b32 v22, s44
    ds_write_b32 v19, v22
    buffer_load_dwordx4 v4, s[8:11], s40 offen offset:0  lds
    s_waitcnt vmcnt(16)
    buffer_load_dwordx4 v5, s[8:11], s40 offen offset:1024  lds
    s_waitcnt vmcnt(16)
    buffer_load_dwordx4 v6, s[8:11], s40 offen offset:2048  lds
    s_waitcnt vmcnt(16)
    buffer_load_dwordx4 v7, s[8:11], s40 offen offset:3072  lds
    s_add_u32 m0, m0, 4096
    s_waitcnt vmcnt(16)
    buffer_load_dwordx4 v4, s[8:11], s41 offen offset:0  lds
    s_waitcnt vmcnt(16)
    buffer_load_dwordx4 v5, s[8:11], s41 offen offset:1024  lds
    s_waitcnt vmcnt(16)
    buffer_load_dwordx4 v6, s[8:11], s41 offen offset:2048  lds
    s_waitcnt vmcnt(16)
    buffer_load_dwordx4 v7, s[8:11], s41 offen offset:3072  lds
    s_mov_b32 m0, s39
    s_waitcnt vmcnt(16)
    s_add_i32 s44, s38, -1
    v_mov_b32 v22, s44
    ds_write_b32 v19, v22
    buffer_load_dwordx4 v4, s[12:15], s31 offen offset:0  lds
    s_waitcnt vmcnt(16)
    buffer_load_dwordx4 v5, s[12:15], s31 offen offset:1024  lds
    s_waitcnt vmcnt(16)
    buffer_load_dwordx4 v6, s[12:15], s31 offen offset:2048  lds
    s_waitcnt vmcnt(16)
    buffer_load_dwordx4 v7, s[12:15], s31 offen offset:3072  lds
    s_add_u32 m0, m0, 4096
    s_waitcnt vmcnt(16)
    buffer_load_dwordx4 v4, s[12:15], s32 offen offset:0  lds
    s_waitcnt vmcnt(16)
    buffer_load_dwordx4 v5, s[12:15], s32 offen offset:1024  lds
    s_waitcnt vmcnt(16)
    buffer_load_dwordx4 v6, s[12:15], s32 offen offset:2048  lds
    s_waitcnt vmcnt(16)
    buffer_load_dwordx4 v7, s[12:15], s32 offen offset:3072  lds
    s_branch L_next
.p2align 8
    s_waitcnt vmcnt(17)
    buffer_load_dwordx4 v4, s[8:11], s40 offen offset:0  lds
    s_waitcnt vmcnt(17)
    s_add_i32 s44, s38, -2
    v_mov_b32 v22, s44
    ds_write_b32 v19, v22
    buffer_load_dwordx4 v5, s[8:11], s40 offen offset:1024  lds
    s_waitcnt vmcnt(17)
    buffer_load_dwordx4 v6, s[8:11], s40 offen offset:2048  lds
    s_waitcnt vmcnt(17)
    buffer_load_dwordx4 v7, s[8:11], s40 offen offset:3072  lds
    s_add_u32 m0, m0, 4096
    s_waitcnt vmcnt(17)
    buffer_load_dwordx4 v4, s[8:11], s41 offen offset:0  lds
    s_waitcnt vmcnt(17)
    buffer_load_dwordx4 v5, s[8:11], s41 offen offset:1024  lds
    s_waitcnt vmcnt(17)
    buffer_load_dwordx4 v6, s[8:11], s41 offen offset:2048  lds
    s_waitcnt vmcnt(17)
    buffer_load_dwordx4 v7, s[8:11], s41 offen offset:3072  lds
    s_mov_b32 m0, s39
    s_waitcnt vmcnt(17)
    buffer_load_dwordx4 v4, s[12:15], s31 offen offset:0  lds
    s_waitcnt vmcnt(17)
    s_add_i32 s44, s38, -1
    v_mov_b32 v22, s44
    ds_write_b32 v19, v22
    buffer_load_dwordx4 v5, s[12:15], s31 offen offset:1024  lds
    s_waitcnt vmcnt(17)
    buffer_load_dwordx4 v6, s[12:15], s31 offen offset:2048  lds
    s_waitcnt vmcnt(17)
    buffer_load_dwordx4 v7, s[12:15], s31 offen offset:3072  lds
    s_add_u32 m0, m0, 4096
    s_waitcnt vmcnt(17)
    buffer_load_dwordx4 v4, s[12:15], s32 offen offset:0  lds
    s_waitcnt vmcnt(17)
    buffer_load_dwordx4 v5, s[12:15], s32 offen offset:1024  lds
    s_waitcnt vmcnt(17)
    buffer_load_dwordx4 v6, s[12:15], s32 offen offset:2048  lds
    s_waitcnt vmcnt(17)
    buffer_load_dwordx4 v7, s[12:15], s32 offen offset:3072  lds
    s_branch L_next
.p2align 8
    s_waitcnt vmcnt(18)
    buffer_load_dwordx4 v4, s[8:11], s40 offen offset:0  lds
    s_waitcnt vmcnt(18)
    buffer_load_dwordx4 v5, s[8:11], s40 offen offset:1024  lds
    s_waitcnt vmcnt(18)
    s_add_i32 s44, s38, -2
    v_mov_b32 v22, s44
    ds_write_b32 v19, v22
    buffer_load_dwordx4 v6, s[8:11], s40 offen offset:2048  lds
    s_waitcnt vmcnt(18)
    buffer_load_dwordx4 v7, s[8:11], s40 offen offset:3072  lds
    s_add_u32 m0, m0, 4096
    s_waitcnt vmcnt(18)
    buffer_load_dwordx4 v4, s[8:11], s41 offen offset:0  lds
    s_waitcnt vmcnt(18)
    buffer_load_dwordx4 v5, s[8:11], s41 offen offset:1024  lds
    s_waitcnt vmcnt(18)
    buffer_load_dwordx4 v6, s[8:11], s41 offen offset:2048  lds
    s_waitcnt vmcnt(18)
    buffer_load_dwordx4 v7, s[8:11], s41 offen offset:3072  lds
    s_mov_b32 m0, s39
    s_waitcnt vmcnt(18)
    buffer_load_dwordx4 v4, s[12:15], s31 offen offset:0  lds
    s_waitcnt vmcnt(18)
    buffer_load_dwordx4 v5, s[12:15], s31 offen offset:1024  lds
    s_waitcnt vmcnt(18)
    s_add_i32 s44, s38, -1
    v_mov_b32 v22, s44
    ds_write_b32 v19, v22
    buffer_load_dwordx4 v6, s[12:15], s31 offen offset:2048  lds
    s_waitcnt vmcnt(18)
    buffer_load_dwordx4 v7, s[12:15], s31 offen offset:3072  lds
    s_add_u32 m0, m0, 4096
    s_waitcnt vmcnt(18)
    buffer_load_dwordx4 v4, s[12:15], s32 offen offset:0  lds
    s_waitcnt vmcnt(18)
    buffer_load_dwordx4 v5, s[12:15], s32 offen offset:1024  lds
    s_waitcnt vmcnt(18)
    buffer_load_dwordx4 v6, s[12:15], s32 offen offset:2048  lds
    s_waitcnt vmcnt(18)
    buffer_load_dwordx4 v7, s[12:15], s32 offen offset:3072  lds
    s_branch L_next
.p2align 8
    s_waitcnt vmcnt(19)
    buffer_load_dwordx4 v4, s[8:11], s40 offen offset:0  lds
    s_waitcnt vmcnt(19)
    buffer_load_dwordx4 v5, s[8:11], s40 offen offset:1024  lds
    s_waitcnt vmcnt(19)
    buffer_load_dwordx4 v6, s[8:11], s40 offen offset:2048  lds
    s_waitcnt vmcnt(19)
    s_add_i32 s44, s38, -2
    v_mov_b32 v22, s44
    ds_write_b32 v19, v22
    buffer_load_dwordx4 v7, s[8:11], s40 offen offset:3072  lds
    s_add_u32 m0, m0, 4096
    s_waitcnt vmcnt(19)
    buffer_load_dwordx4 v4, s[8:11], s41 offen offset:0  lds
    s_waitcnt vmcnt(19)
    buffer_load_dwordx4 v5, s[8:11], s41 offen offset:1024  lds
    s_waitcnt vmcnt(19)
    buffer_load_dwordx4 v6, s[8:11], s41 offen offset:2048  lds
    s_waitcnt vmcnt(19)
    buffer_load_dwordx4 v7, s[8:11], s41 offen offset:3072  lds
    s_mov_b32 m0, s39
    s_waitcnt vmcnt(19)
    buffer_load_dwordx4 v4, s[12:15], s31 offen offset:0  lds
    s_waitcnt vmcnt(19)
    buffer_load_dwordx4 v5, s[12:15], s31 offen offset:1024  lds
    s_waitcnt vmcnt(19)
    buffer_load_dwordx4 v6, s[12:15], s31 offen offset:2048  lds
    s_waitcnt vmcnt(19)
    s_add_i32 s44, s38, -1
    v_mov_b32 v22, s44
    ds_write_b32 v19, v22
    buffer_load_dwordx4 v7, s[12:15], s31 offen offset:3072  lds
    s_add_u32 m0, m0, 4096
    s_waitcnt vmcnt(19)
    buffer_load_dwordx4 v4, s[12:15], s32 offen offset:0  lds
    s_waitcnt vmcnt(19)
    buffer_load_dwordx4 v5, s[12:15], s32 offen offset:1024  lds
    s_waitcnt vmcnt(19)
    buffer_load_dwordx4 v6, s[12:15], s32 offen offset:2048  lds
    s_waitcnt vmcnt(19)
    buffer_load_dwordx4 v7, s[12:15], s32 offen offset:3072  lds
    s_branch L_next
.p2align 8
    s_waitcnt vmcnt(20)
    buffer_load_dwordx4 v4, s[8:11], s40 offen offset:0  lds
    s_waitcnt vmcnt(20)
    buffer_load_dwordx4 v5, s[8:11], s40 offen offset:1024  lds
    s_waitcnt vmcnt(20)
    buffer_load_dwordx4 v6, s[8:11], s40 offen offset:2048  lds
    s_waitcnt vmcnt(20)
    buffer_load_dwordx4 v7, s[8:11], s40 offen offset:3072  lds
    s_add_u32 m0, m0, 4096
    s_waitcnt vmcnt(20)
    s_add_i32 s44, s38, -2
    v_mov_b32 v22, s44
    ds_write_b32 v19, v22
    buffer_load_dwordx4 v4, s[8:11], s41 offen offset:0  lds
    s_waitcnt vmcnt(20)
    buffer_load_dwordx4 v5, s[8:11], s41 offen offset:1024  lds
    s_waitcnt vmcnt(20)
    buffer_load_dwordx4 v6, s[8:11], s41 offen offset:2048  lds
    s_waitcnt vmcnt(20)
    buffer_load_dwordx4 v7, s[8:11], s41 offen offset:3072  lds
    s_mov_b32 m0, s39
    s_waitcnt vmcnt(20)
    buffer_load_dwordx4 v4, s[12:15], s31 offen offset:0  lds
    s_waitcnt vmcnt(20)
    buffer_load_dwordx4 v5, s[12:15], s31 offen offset:1024  lds
    s_waitcnt vmcnt(20)
    buffer_load_dwordx4 v6, s[12:15], s31 offen offset:2048  lds
    s_waitcnt vmcnt(20)
    buffer_load_dwordx4 v7, s[12:15], s31 offen offset:3072  lds
    s_add_u32 m0, m0, 4096
    s_waitcnt vmcnt(20)
    s_add_i32 s44, s38, -1
    v_mov_b32 v22, s44
    ds_write_b32 v19, v22
    buffer_load_dwordx4 v4, s[12:15], s32 offen offset:0  lds
    s_waitcnt vmcnt(20)
    buffer_load_dwordx4 v5, s[12:15], s32 offen offset:1024  lds
    s_waitcnt vmcnt(20)
    buffer_load_dwordx4 v6, s[12:15], s32 offen offset:2048  lds
    s_waitcnt vmcnt(20)
    buffer_load_dwordx4 v7, s[12:15], s32 offen offset:3072  lds
    s_branch L_next
.p2align 8
    s_waitcnt vmcnt(21)
    buffer_load_dwordx4 v4, s[8:11], s40 offen offset:0  lds
    s_waitcnt vmcnt(21)
    buffer_load_dwordx4 v5, s[8:11], s40 offen offset:1024  lds
    s_waitcnt vmcnt(21)
    buffer_load_dwordx4 v6, s[8:11], s40 offen offset:2048  lds
    s_waitcnt vmcnt(21)
    buffer_load_dwordx4 v7, s[8:11], s40 offen offset:3072  lds
    s_add_u32 m0, m0, 4096
    s_waitcnt vmcnt(21)
    buffer_load_dwordx4 v4, s[8:11], s41 offen offset:0  lds
    s_waitcnt vmcnt(21)
    s_add_i32 s44, s38, -2
    v_mov_b32 v22, s44
    ds_write_b32 v19, v22
    buffer_load_dwordx4 v5, s[8:11], s41 offen offset:1024  lds
    s_waitcnt vmcnt(21)
    buffer_load_dwordx4 v6, s[8:11], s41 offen offset:2048  lds
    s_waitcnt vmcnt(21)
    buffer_load_dwordx4 v7, s[8:11], s41 offen offset:3072  lds
    s_mov_b32 m0, s39
    s_waitcnt vmcnt(21)
    buffer_load_dwordx4 v4, s[12:15], s31 offen offset:0  lds
    s_waitcnt vmcnt(21)
    buffer_load_dwordx4 v5, s[12:15], s31 offen offset:1024  lds
    s_waitcnt vmcnt(21)
    buffer_load_dwordx4 v6, s[12:15], s31 offen offset:2048  lds
    s_waitcnt vmcnt(21)
    buffer_load_dwordx4 v7, s[12:15], s31 offen offset:3072  lds
    s_add_u32 m0, m0, 4096
    s_waitcnt vmcnt(21)
    buffer_load_dwordx4 v4, s[12:15], s32 offen offset:0  lds
    s_waitcnt vmcnt(21)
    s_add_i32 s44, s38, -1
    v_mov_b32 v22, s44
    ds_write_b32 v19, v22
    buffer_load_dwordx4 v5, s[12:15], s32 offen offset:1024  lds
    s_waitcnt vmcnt(21)
    buffer_load_dwordx4 v6, s[12:15], s32 offen offset:2048  lds
    s_waitcnt vmcnt(21)
    buffer_load_dwordx4 v7, s[12:15], s32 offen offset:3072  lds
    s_branch L_next
.p2align 8
    s_waitcnt vmcnt(22)
    buffer_load_dwordx4 v4, s[8:11], s40 offen offset:0  lds
    s_waitcnt vmcnt(22)
    buffer_load_dwordx4 v5, s[8:11], s40 offen offset:1024  lds
    s_waitcnt vmcnt(22)
    buffer_load_dwordx4 v6, s[8:11], s40 offen offset:2048  lds
    s_waitcnt vmcnt(22)
    buffer_load_dwordx4 v7, s[8:11], s40 offen offset:3072  lds
    s_add_u32 m0, m0, 4096
    s_waitcnt vmcnt(22)
    buffer_load_dwordx4 v4, s[8:11], s41 offen offset:0  lds
    s_waitcnt vmcnt(22)
    buffer_load_dwordx4 v5, s[8:11], s41 offen offset:1024  lds
    s_waitcnt vmcnt(22)
    s_add_i32 s44, s38, -2
    v_mov_b32 v22, s44
    ds_write_b32 v19, v22
    buffer_load_dwordx4 v6, s[8:11], s41 offen offset:2048  lds
    s_waitcnt vmcnt(22)
    buffer_load_dwordx4 v7, s[8:11], s41 offen offset:3072  lds
    s_mov_b32 m0, s39
    s_waitcnt vmcnt(22)
    buffer_load_dwordx4 v4, s[12:15], s31 offen offset:0  lds
    s_waitcnt vmcnt(22)
    buffer_load_dwordx4 v5, s[12:15], s31 offen offset:1024  lds
    s_waitcnt vmcnt(22)
    buffer_load_dwordx4 v6, s[12:15], s31 offen offset:2048  lds
    s_waitcnt vmcnt(22)
    buffer_load_dwordx4 v7, s[12:15], s31 offen offset:3072  lds
    s_add_u32 m0, m0, 4096
    s_waitcnt vmcnt(22)
    buffer_load_dwordx4 v4, s[12:15], s32 offen offset:0  lds
    s_waitcnt vmcnt(22)
    buffer_load_dwordx4 v5, s[12:15], s32 offen offset:1024  lds
    s_waitcnt vmcnt(22)
    s_add_i32 s44, s38, -1
    v_mov_b32 v22, s44
    ds_write_b32 v19, v22
    buffer_load_dwordx4 v6, s[12:15], s32 offen offset:2048  lds
    s_waitcnt vmcnt(22)
    buffer_load_dwordx4 v7, s[12:15], s32 offen offset:3072  lds
    s_branch L_next
.p2align 8
    s_waitcnt vmcnt(23)
    buffer_load_dwordx4 v4, s[8:11], s40 offen offset:0  lds
    s_waitcnt vmcnt(23)
    buffer_load_dwordx4 v5, s[8:11], s40 offen offset:1024  lds
    s_waitcnt vmcnt(23)
    buffer_load_dwordx4 v6, s[8:11], s40 offen offset:2048  lds
    s_waitcnt vmcnt(23)
    buffer_load_dwordx4 v7, s[8:11], s40 offen offset:3072  lds
    s_add_u32 m0, m0, 4096
    s_waitcnt vmcnt(23)
    buffer_load_dwordx4 v4, s[8:11], s41 offen offset:0  lds
    s_waitcnt vmcnt(23)
    buffer_load_dwordx4 v5, s[8:11], s41 offen offset:1024  lds
    s_waitcnt vmcnt(23)
    buffer_load_dwordx4 v6, s[8:11], s41 offen offset:2048  lds
    s_waitcnt vmcnt(23)
    s_add_i32 s44, s38, -2
    v_mov_b32 v22, s44
    ds_write_b32 v19, v22
    buffer_load_dwordx4 v7, s[8:11], s41 offen offset:3072  lds
    s_mov_b32 m0, s39
    s_waitcnt vmcnt(23)
    buffer_load_dwordx4 v4, s[12:15], s31 offen offset:0  lds
    s_waitcnt vmcnt(23)
    buffer_load_dwordx4 v5, s[12:15], s31 offen offset:1024  lds
    s_waitcnt vmcnt(23)
    buffer_load_dwordx4 v6, s[12:15], s31 offen offset:2048  lds
    s_waitcnt vmcnt(23)
    buffer_load_dwordx4 v7, s[12:15], s31 offen offset:3072  lds
    s_add_u32 m0, m0, 4096
    s_waitcnt vmcnt(23)
    buffer_load_dwordx4 v4, s[12:15], s32 offen offset:0  lds
    s_waitcnt vmcnt(23)
    buffer_load_dwordx4 v5, s[12:15], s32 offen offset:1024  lds
    s_waitcnt vmcnt(23)
    buffer_load_dwordx4 v6, s[12:15], s32 offen offset:2048  lds
    s_waitcnt vmcnt(23)
    s_add_i32 s44, s38, -1
    v_mov_b32 v22, s44
    ds_write_b32 v19, v22
    buffer_load_dwordx4 v7, s[12:15], s32 offen offset:3072  lds
    s_branch L_next
.p2align 8
    s_waitcnt vmcnt(24)
    s_add_i32 s44, s38, -3
    v_mov_b32 v22, s44
    ds_write_b32 v19, v22
    buffer_load_dwordx4 v4, s[8:11], s40 offen offset:0  lds
    s_waitcnt vmcnt(24)
    buffer_load_dwordx4 v5, s[8:11], s40 offen offset:1024  lds
    s_waitcnt vmcnt(24)
    buffer_load_dwordx4 v6, s[8:11], s40 offen offset:2048  lds
    s_waitcnt vmcnt(24)
    buffer_load_dwordx4 v7, s[8:11], s40 offen offset:3072  lds
    s_add_u32 m0, m0, 4096
    s_waitcnt vmcnt(24)
    buffer_load_dwordx4 v4, s[8:11], s41 offen offset:0  lds
    s_waitcnt vmcnt(24)
    buffer_load_dwordx4 v5, s[8:11], s41 offen offset:1024  lds
    s_waitcnt vmcnt(24)
    buffer_load_dwordx4 v6, s[8:11], s41 offen offset:2048  lds
    s_waitcnt vmcnt(24)
    buffer_load_dwordx4 v7, s[8:11], s41 offen offset:3072  lds
    s_mov_b32 m0, s39
    s_waitcnt vmcnt(24)
    s_add_i32 s44, s38, -2
    v_mov_b32 v22, s44
    ds_write_b32 v19, v22
    buffer_load_dwordx4 v4, s[12:15], s31 offen offset:0  lds
    s_waitcnt vmcnt(24)
    buffer_load_dwordx4 v5, s[12:15], s31 offen offset:1024  lds
    s_waitcnt vmcnt(24)
    buffer_load_dwordx4 v6, s[12:15], s31 offen offset:2048  lds
    s_waitcnt vmcnt(24)
    buffer_load_dwordx4 v7, s[12:15], s31 offen offset:3072  lds
    s_add_u32 m0, m0, 4096
    s_waitcnt vmcnt(24)
    buffer_load_dwordx4 v4, s[12:15], s32 offen offset:0  lds
    s_waitcnt vmcnt(24)
    buffer_load_dwordx4 v5, s[12:15], s32 offen offset:1024  lds
    s_waitcnt vmcnt(24)
    buffer_load_dwordx4 v6, s[12:15], s32 offen offset:2048  lds
    s_waitcnt vmcnt(24)
    buffer_load_dwordx4 v7, s[12:15], s32 offen offset:3072  lds
    s_branch L_next
.p2align 8
    s_waitcnt vmcnt(25)
    buffer_load_dwordx4 v4, s[8:11], s40 offen offset:0  lds
    s_waitcnt vmcnt(25)
    s_add_i32 s44, s38, -3
    v_mov_b32 v22, s44
    ds_write_b32 v19, v22
    buffer_load_dwordx4 v5, s[8:11], s40 offen offset:1024  lds
    s_waitcnt vmcnt(25)
    buffer_load_dwordx4 v6, s[8:11], s40 offen offset:2048  lds
    s_waitcnt vmcnt(25)
    buffer_load_dwordx4 v7, s[8:11], s40 offen offset:3072  lds
    s_add_u32 m0, m0, 4096
    s_waitcnt vmcnt(25)
    buffer_load_dwordx4 v4, s[8:11], s41 offen offset:0  lds
    s_waitcnt vmcnt(25)
    buffer_load_dwordx4 v5, s[8:11], s41 offen offset:1024  lds
    s_waitcnt vmcnt(25)
    buffer_load_dwordx4 v6, s[8:11], s41 offen offset:2048  lds
    s_waitcnt vmcnt(25)
    buffer_load_dwordx4 v7, s[8:11], s41 offen offset:3072  lds
    s_mov_b32 m0, s39
    s_waitcnt vmcnt(25)
    buffer_load_dwordx4 v4, s[12:15], s31 offen offset:0  lds
    s_waitcnt vmcnt(25)
    s_add_i32 s44, s38, -2
    v_mov_b32 v22, s44
    ds_write_b32 v19, v22
    buffer_load_dwordx4 v5, s[12:15], s31 offen offset:1024  lds
    s_waitcnt vmcnt(25)
    buffer_load_dwordx4 v6, s[12:15], s31 offen offset:2048  lds
    s_waitcnt vmcnt(25)
    buffer_load_dwordx4 v7, s[12:15], s31 offen offset:3072  lds
    s_add_u32 m0, m0, 4096
    s_waitcnt vmcnt(25)
    buffer_load_dwordx4 v4, s[12:15], s32 offen offset:0  lds
    s_waitcnt vmcnt(25)
    buffer_load_dwordx4 v5, s[12:15], s32 offen offset:1024  lds
    s_waitcnt vmcnt(25)
    buffer_load_dwordx4 v6, s[12:15], s32 offen offset:2048  lds
    s_waitcnt vmcnt(25)
    buffer_load_dwordx4 v7, s[12:15], s32 offen offset:3072  lds
    s_branch L_next
.p2align 8
    s_waitcnt vmcnt(26)
    buffer_load_dwordx4 v4, s[8:11], s40 offen offset:0  lds
    s_waitcnt vmcnt(26)
    buffer_load_dwordx4 v5, s[8:11], s40 offen offset:1024  lds
    s_waitcnt vmcnt(26)
    s_add_i32 s44, s38, -3
    v_mov_b32 v22, s44
    ds_write_b32 v19, v22
    buffer_load_dwordx4 v6, s[8:11], s40 offen offset:2048  lds
    s_waitcnt vmcnt(26)
    buffer_load_dwordx4 v7, s[8:11], s40 offen offset:3072  lds
    s_add_u32 m0, m0, 4096
    s_waitcnt vmcnt(26)
    buffer_load_dwordx4 v4, s[8:11], s41 offen offset:0  lds
    s_waitcnt vmcnt(26)
    buffer_load_dwordx4 v5, s[8:11], s41 offen offset:1024  lds
    s_waitcnt vmcnt(26)
    buffer_load_dwordx4 v6, s[8:11], s41 offen offset:2048  lds
    s_waitcnt vmcnt(26)
    buffer_load_dwordx4 v7, s[8:11], s41 offen offset:3072  lds
    s_mov_b32 m0, s39
    s_waitcnt vmcnt(26)
    buffer_load_dwordx4 v4, s[12:15], s31 offen offset:0  lds
    s_waitcnt vmcnt(26)
    buffer_load_dwordx4 v5, s[12:15], s31 offen offset:1024  lds
    s_waitcnt vmcnt(26)
    s_add_i32 s44, s38, -2
    v_mov_b32 v22, s44
    ds_write_b32 v19, v22
    buffer_load_dwordx4 v6, s[12:15], s31 offen offset:2048  lds
    s_waitcnt vmcnt(26)
    buffer_load_dwordx4 v7, s[12:15], s31 offen offset:3072  lds
    s_add_u32 m0, m0, 4096
    s_waitcnt vmcnt(26)
    buffer_load_dwordx4 v4, s[12:15], s32 offen offset:0  lds
    s_waitcnt vmcnt(26)
    buffer_load_dwordx4 v5, s[12:15], s32 offen offset:1024  lds
    s_waitcnt vmcnt(26)
    buffer_load_dwordx4 v6, s[12:15], s32 offen offset:2048  lds
    s_waitcnt vmcnt(26)
    buffer_load_dwordx4 v7, s[12:15], s32 offen offset:3072  lds
    s_branch L_next
.p2align 8
    s_waitcnt vmcnt(27)
    buffer_load_dwordx4 v4, s[8:11], s40 offen offset:0  lds
    s_waitcnt vmcnt(27)
    buffer_load_dwordx4 v5, s[8:11], s40 offen offset:1024  lds
    s_waitcnt vmcnt(27)
    buffer_load_dwordx4 v6, s[8:11], s40 offen offset:2048  lds
    s_waitcnt vmcnt(27)
    s_add_i32 s44, s38, -3
    v_mov_b32 v22, s44
    ds_write_b32 v19, v22
    buffer_load_dwordx4 v7, s[8:11], s40 offen offset:3072  lds
    s_add_u32 m0, m0, 4096
    s_waitcnt vmcnt(27)
    buffer_load_dwordx4 v4, s[8:11], s41 offen offset:0  lds
    s_waitcnt vmcnt(27)
    buffer_load_dwordx4 v5, s[8:11], s41 offen offset:1024  lds
    s_waitcnt vmcnt(27)
    buffer_load_dwordx4 v6, s[8:11], s41 offen offset:2048  lds
    s_waitcnt vmcnt(27)
    buffer_load_dwordx4 v7, s[8:11], s41 offen offset:3072  lds
    s_mov_b32 m0, s39
    s_waitcnt vmcnt(27)
    buffer_load_dwordx4 v4, s[12:15], s31 offen offset:0  lds
    s_waitcnt vmcnt(27)
    buffer_load_dwordx4 v5, s[12:15], s31 offen offset:1024  lds
    s_waitcnt vmcnt(27)
    buffer_load_dwordx4 v6, s[12:15], s31 offen offset:2048  lds
    s_waitcnt vmcnt(27)
    s_add_i32 s44, s38, -2
    v_mov_b32 v22, s44
    ds_write_b32 v19, v22
    buffer_load_dwordx4 v7, s[12:15], s31 offen offset:3072  lds
    s_add_u32 m0, m0, 4096
    s_waitcnt vmcnt(27)
    buffer_load_dwordx4 v4, s[12:15], s32 offen offset:0  lds
    s_waitcnt vmcnt(27)
    buffer_load_dwordx4 v5, s[12:15], s32 offen offset:1024  lds
    s_waitcnt vmcnt(27)
    buffer_load_dwordx4 v6, s[12:15], s32 offen offset:2048  lds
    s_waitcnt vmcnt(27)
    buffer_load_dwordx4 v7, s[12:15], s32 offen offset:3072  lds
    s_branch L_next
.p2align 8
    s_waitcnt vmcnt(28)
    buffer_load_dwordx4 v4, s[8:11], s40 offen offset:0  lds
    s_waitcnt vmcnt(28)
    buffer_load_dwordx4 v5, s[8:11], s40 offen offset:1024  lds
    s_waitcnt vmcnt(28)
    buffer_load_dwordx4 v6, s[8:11], s40 offen offset:2048  lds
    s_waitcnt vmcnt(28)
    buffer_load_dwordx4 v7, s[8:11], s40 offen offset:3072  lds
    s_add_u32 m0, m0, 4096
    s_waitcnt vmcnt(28)
    s_add_i32 s44, s38, -3
    v_mov_b32 v22, s44
    ds_write_b32 v19, v22
    buffer_load_dwordx4 v4, s[8:11], s41 offen offset:0  lds
    s_waitcnt vmcnt(28)
    buffer_load_dwordx4 v5, s[8:11], s41 offen offset:1024  lds
    s_waitcnt vmcnt(28)
    buffer_load_dwordx4 v6, s[8:11], s41 offen offset:2048  lds
    s_waitcnt vmcnt(28)
    buffer_load_dwordx4 v7, s[8:11], s41 offen offset:3072  lds
    s_mov_b32 m0, s39
    s_waitcnt vmcnt(28)
    buffer_load_dwordx4 v4, s[12:15], s31 offen offset:0  lds
    s_waitcnt vmcnt(28)
    buffer_load_dwordx4 v5, s[12:15], s31 offen offset:1024  lds
    s_waitcnt vmcnt(28)
    buffer_load_dwordx4 v6, s[12:15], s31 offen offset:2048  lds
    s_waitcnt vmcnt(28)
    buffer_load_dwordx4 v7, s[12:15], s31 offen offset:3072  lds
    s_add_u32 m0, m0, 4096
    s_waitcnt vmcnt(28)
    s_add_i32 s44, s38, -2
    v_mov_b32 v22, s44
    ds_write_b32 v19, v22
    buffer_load_dwordx4 v4, s[12:15], s32 offen offset:0  lds
    s_waitcnt vmcnt(28)
    buffer_load_dwordx4 v5, s[12:15], s32 offen offset:1024  lds
    s_waitcnt vmcnt(28)
    buffer_load_dwordx4 v6, s[12:15], s32 offen offset:2048  lds
    s_waitcnt vmcnt(28)
    buffer_load_dwordx4 v7, s[12:15], s32 offen offset:3072  lds
    s_branch L_next
.p2align 8
    s_waitcnt vmcnt(29)
    buffer_load_dwordx4 v4, s[8:11], s40 offen offset:0  lds
    s_waitcnt vmcnt(29)
    buffer_load_dwordx4 v5, s[8:11], s40 offen offset:1024  lds
    s_waitcnt vmcnt(29)
    buffer_load_dwordx4 v6, s[8:11], s40 offen offset:2048  lds
    s_waitcnt vmcnt(29)
    buffer_load_dwordx4 v7, s[8:11], s40 offen offset:3072  lds
    s_add_u32 m0, m0, 4096
    s_waitcnt vmcnt(29)
    buffer_load_dwordx4 v4, s[8:11], s41 offen offset:0  lds
    s_waitcnt vmcnt(29)
    s_add_i32 s44, s38, -3
    v_mov_b32 v22, s44
    ds_write_b32 v19, v22
    buffer_load_dwordx4 v5, s[8:11], s41 offen offset:1024  lds
    s_waitcnt vmcnt(29)
    buffer_load_dwordx4 v6, s[8:11], s41 offen offset:2048  lds
    s_waitcnt vmcnt(29)
    buffer_load_dwordx4 v7, s[8:11], s41 offen offset:3072  lds
    s_mov_b32 m0, s39
    s_waitcnt vmcnt(29)
    buffer_load_dwordx4 v4, s[12:15], s31 offen offset:0  lds
    s_waitcnt vmcnt(29)
    buffer_load_dwordx4 v5, s[12:15], s31 offen offset:1024  lds
    s_waitcnt vmcnt(29)
    buffer_load_dwordx4 v6, s[12:15], s31 offen offset:2048  lds
    s_waitcnt vmcnt(29)
    buffer_load_dwordx4 v7, s[12:15], s31 offen offset:3072  lds
    s_add_u32 m0, m0, 4096
    s_waitcnt vmcnt(29)
    buffer_load_dwordx4 v4, s[12:15], s32 offen offset:0  lds
    s_waitcnt vmcnt(29)
    s_add_i32 s44, s38, -2
    v_mov_b32 v22, s44
    ds_write_b32 v19, v22
    buffer_load_dwordx4 v5, s[12:15], s32 offen offset:1024  lds
    s_waitcnt vmcnt(29)
    buffer_load_dwordx4 v6, s[12:15], s32 offen offset:2048  lds
    s_waitcnt vmcnt(29)
    buffer_load_dwordx4 v7, s[12:15], s32 offen offset:3072  lds
    s_branch L_next
.p2align 8
    s_waitcnt vmcnt(30)
    buffer_load_dwordx4 v4, s[8:11], s40 offen offset:0  lds
    s_waitcnt vmcnt(30)
    buffer_load_dwordx4 v5, s[8:11], s40 offen offset:1024  lds
    s_waitcnt vmcnt(30)
    buffer_load_dwordx4 v6, s[8:11], s40 offen offset:2048  lds
    s_waitcnt vmcnt(30)
    buffer_load_dwordx4 v7, s[8:11], s40 offen offset:3072  lds
    s_add_u32 m0, m0, 4096
    s_waitcnt vmcnt(30)
    buffer_load_dwordx4 v4, s[8:11], s41 offen offset:0  lds
    s_waitcnt vmcnt(30)
    buffer_load_dwordx4 v5, s[8:11], s41 offen offset:1024  lds
    s_waitcnt vmcnt(30)
    s_add_i32 s44, s38, -3
    v_mov_b32 v22, s44
    ds_write_b32 v19, v22
    buffer_load_dwordx4 v6, s[8:11], s41 offen offset:2048  lds
    s_waitcnt vmcnt(30)
    buffer_load_dwordx4 v7, s[8:11], s41 offen offset:3072  lds
    s_mov_b32 m0, s39
    s_waitcnt vmcnt(30)
    buffer_load_dwordx4 v4, s[12:15], s31 offen offset:0  lds
    s_waitcnt vmcnt(30)
    buffer_load_dwordx4 v5, s[12:15], s31 offen offset:1024  lds
    s_waitcnt vmcnt(30)
    buffer_load_dwordx4 v6, s[12:15], s31 offen offset:2048  lds
    s_waitcnt vmcnt(30)
    buffer_load_dwordx4 v7, s[12:15], s31 offen offset:3072  lds
    s_add_u32 m0, m0, 4096
    s_waitcnt vmcnt(30)
    buffer_load_dwordx4 v4, s[12:15], s32 offen offset:0  lds
    s_waitcnt vmcnt(30)
    buffer_load_dwordx4 v5, s[12:15], s32 offen offset:1024  lds
    s_waitcnt vmcnt(30)
    s_add_i32 s44, s38, -2
    v_mov_b32 v22, s44
    ds_write_b32 v19, v22
    buffer_load_dwordx4 v6, s[12:15], s32 offen offset:2048  lds
    s_waitcnt vmcnt(30)
    buffer_load_dwordx4 v7, s[12:15], s32 offen offset:3072  lds
    s_branch L_next
.p2align 8
    s_waitcnt vmcnt(31)
    buffer_load_dwordx4 v4, s[8:11], s40 offen offset:0  lds
    s_waitcnt vmcnt(31)
    buffer_load_dwordx4 v5, s[8:11], s40 offen offset:1024  lds
    s_waitcnt vmcnt(31)
    buffer_load_dwordx4 v6, s[8:11], s40 offen offset:2048  lds
    s_waitcnt vmcnt(31)
    buffer_load_dwordx4 v7, s[8:11], s40 offen offset:3072  lds
    s_add_u32 m0, m0, 4096
    s_waitcnt vmcnt(31)
    buffer_load_dwordx4 v4, s[8:11], s41 offen offset:0  lds
    s_waitcnt vmcnt(31)
    buffer_load_dwordx4 v5, s[8:11], s41 offen offset:1024  lds
    s_waitcnt vmcnt(31)
    buffer_load_dwordx4 v6, s[8:11], s41 offen offset:2048  lds
    s_waitcnt vmcnt(31)
    s_add_i32 s44, s38, -3
    v_mov_b32 v22, s44
    ds_write_b32 v19, v22
    buffer_load_dwordx4 v7, s[8:11], s41 offen offset:3072  lds
    s_mov_b32 m0, s39
    s_waitcnt vmcnt(31)
    buffer_load_dwordx4 v4, s[12:15], s31 offen offset:0  lds
    s_waitcnt vmcnt(31)
    buffer_load_dwordx4 v5, s[12:15], s31 offen offset:1024  lds
    s_waitcnt vmcnt(31)
    buffer_load_dwordx4 v6, s[12:15], s31 offen offset:2048  lds
    s_waitcnt vmcnt(31)
    buffer_load_dwordx4 v7, s[12:15], s31 offen offset:3072  lds
    s_add_u32 m0, m0, 4096
    s_waitcnt vmcnt(31)
    buffer_load_dwordx4 v4, s[12:15], s32 offen offset:0  lds
    s_waitcnt vmcnt(31)
    buffer_load_dwordx4 v5, s[12:15], s32 offen offset:1024  lds
    s_waitcnt vmcnt(31)
    buffer_load_dwordx4 v6, s[12:15], s32 offen offset:2048  lds
    s_waitcnt vmcnt(31)
    s_add_i32 s44, s38, -2
    v_mov_b32 v22, s44
    ds_write_b32 v19, v22
    buffer_load_dwordx4 v7, s[12:15], s32 offen offset:3072  lds
    s_branch L_next
.p2align 8
    s_waitcnt vmcnt(32)
    s_add_i32 s44, s38, -4
    v_mov_b32 v22, s44
    ds_write_b32 v19, v22
    buffer_load_dwordx4 v4, s[8:11], s40 offen offset:0  lds
    s_waitcnt vmcnt(32)
    buffer_load_dwordx4 v5, s[8:11], s40 offen offset:1024  lds
    s_waitcnt vmcnt(32)
    buffer_load_dwordx4 v6, s[8:11], s40 offen offset:2048  lds
    s_waitcnt vmcnt(32)
    buffer_load_dwordx4 v7, s[8:11], s40 offen offset:3072  lds
    s_add_u32 m0, m0, 4096
    s_waitcnt vmcnt(32)
    buffer_load_dwordx4 v4, s[8:11], s41 offen offset:0  lds
    s_waitcnt vmcnt(32)
    buffer_load_dwordx4 v5, s[8:11], s41 offen offset:1024  lds
    s_waitcnt vmcnt(32)
    buffer_load_dwordx4 v6, s[8:11], s41 offen offset:2048  lds
    s_waitcnt vmcnt(32)
    buffer_load_dwordx4 v7, s[8:11], s41 offen offset:3072  lds
    s_mov_b32 m0, s39
    s_waitcnt vmcnt(32)
    s_add_i32 s44, s38, -3
    v_mov_b32 v22, s44
    ds_write_b32 v19, v22
    buffer_load_dwordx4 v4, s[12:15], s31 offen offset:0  lds
    s_waitcnt vmcnt(32)
    buffer_load_dwordx4 v5, s[12:15], s31 offen offset:1024  lds
    s_waitcnt vmcnt(32)
    buffer_load_dwordx4 v6, s[12:15], s31 offen offset:2048  lds
    s_waitcnt vmcnt(32)
    buffer_load_dwordx4 v7, s[12:15], s31 offen offset:3072  lds
    s_add_u32 m0, m0, 4096
    s_waitcnt vmcnt(32)
    buffer_load_dwordx4 v4, s[12:15], s32 offen offset:0  lds
    s_waitcnt vmcnt(32)
    buffer_load_dwordx4 v5, s[12:15], s32 offen offset:1024  lds
    s_waitcnt vmcnt(32)
    buffer_load_dwordx4 v6, s[12:15], s32 offen offset:2048  lds
    s_waitcnt vmcnt(32)
    buffer_load_dwordx4 v7, s[12:15], s32 offen offset:3072  lds
    s_branch L_next
.p2align 8
    s_waitcnt vmcnt(33)
    buffer_load_dwordx4 v4, s[8:11], s40 offen offset:0  lds
    s_waitcnt vmcnt(33)
    s_add_i32 s44, s38, -4
    v_mov_b32 v22, s44
    ds_write_b32 v19, v22
    buffer_load_dwordx4 v5, s[8:11], s40 offen offset:1024  lds
    s_waitcnt vmcnt(33)
    buffer_load_dwordx4 v6, s[8:11], s40 offen offset:2048  lds
    s_waitcnt vmcnt(33)
    buffer_load_dwordx4 v7, s[8:11], s40 offen offset:3072  lds
    s_add_u32 m0, m0, 4096
    s_waitcnt vmcnt(33)
    buffer_load_dwordx4 v4, s[8:11], s41 offen offset:0  lds
    s_waitcnt vmcnt(33)
    buffer_load_dwordx4 v5, s[8:11], s41 offen offset:1024  lds
    s_waitcnt vmcnt(33)
    buffer_load_dwordx4 v6, s[8:11], s41 offen offset:2048  lds
    s_waitcnt vmcnt(33)
    buffer_load_dwordx4 v7, s[8:11], s41 offen offset:3072  lds
    s_mov_b32 m0, s39
    s_waitcnt vmcnt(33)
    buffer_load_dwordx4 v4, s[12:15], s31 offen offset:0  lds
    s_waitcnt vmcnt(33)
    s_add_i32 s44, s38, -3
    v_mov_b32 v22, s44
    ds_write_b32 v19, v22
    buffer_load_dwordx4 v5, s[12:15], s31 offen offset:1024  lds
    s_waitcnt vmcnt(33)
    buffer_load_dwordx4 v6, s[12:15], s31 offen offset:2048  lds
    s_waitcnt vmcnt(33)
    buffer_load_dwordx4 v7, s[12:15], s31 offen offset:3072  lds
    s_add_u32 m0, m0, 4096
    s_waitcnt vmcnt(33)
    buffer_load_dwordx4 v4, s[12:15], s32 offen offset:0  lds
    s_waitcnt vmcnt(33)
    buffer_load_dwordx4 v5, s[12:15], s32 offen offset:1024  lds
    s_waitcnt vmcnt(33)
    buffer_load_dwordx4 v6, s[12:15], s32 offen offset:2048  lds
    s_waitcnt vmcnt(33)
    buffer_load_dwordx4 v7, s[12:15], s32 offen offset:3072  lds
    s_branch L_next
.p2align 8
    s_waitcnt vmcnt(34)
    buffer_load_dwordx4 v4, s[8:11], s40 offen offset:0  lds
    s_waitcnt vmcnt(34)
    buffer_load_dwordx4 v5, s[8:11], s40 offen offset:1024  lds
    s_waitcnt vmcnt(34)
    s_add_i32 s44, s38, -4
    v_mov_b32 v22, s44
    ds_write_b32 v19, v22
    buffer_load_dwordx4 v6, s[8:11], s40 offen offset:2048  lds
    s_waitcnt vmcnt(34)
    buffer_load_dwordx4 v7, s[8:11], s40 offen offset:3072  lds
    s_add_u32 m0, m0, 4096
    s_waitcnt vmcnt(34)
    buffer_load_dwordx4 v4, s[8:11], s41 offen offset:0  lds
    s_waitcnt vmcnt(34)
    buffer_load_dwordx4 v5, s[8:11], s41 offen offset:1024  lds
    s_waitcnt vmcnt(34)
    buffer_load_dwordx4 v6, s[8:11], s41 offen offset:2048  lds
    s_waitcnt vmcnt(34)
    buffer_load_dwordx4 v7, s[8:11], s41 offen offset:3072  lds
    s_mov_b32 m0, s39
    s_waitcnt vmcnt(34)
    buffer_load_dwordx4 v4, s[12:15], s31 offen offset:0  lds
    s_waitcnt vmcnt(34)
    buffer_load_dwordx4 v5, s[12:15], s31 offen offset:1024  lds
    s_waitcnt vmcnt(34)
    s_add_i32 s44, s38, -3
    v_mov_b32 v22, s44
    ds_write_b32 v19, v22
    buffer_load_dwordx4 v6, s[12:15], s31 offen offset:2048  lds
    s_waitcnt vmcnt(34)
    buffer_load_dwordx4 v7, s[12:15], s31 offen offset:3072  lds
    s_add_u32 m0, m0, 4096
    s_waitcnt vmcnt(34)
    buffer_load_dwordx4 v4, s[12:15], s32 offen offset:0  lds
    s_waitcnt vmcnt(34)
    buffer_load_dwordx4 v5, s[12:15], s32 offen offset:1024  lds
    s_waitcnt vmcnt(34)
    buffer_load_dwordx4 v6, s[12:15], s32 offen offset:2048  lds
    s_waitcnt vmcnt(34)
    buffer_load_dwordx4 v7, s[12:15], s32 offen offset:3072  lds
    s_branch L_next
.p2align 8
    s_waitcnt vmcnt(35)
    buffer_load_dwordx4 v4, s[8:11], s40 offen offset:0  lds
    s_waitcnt vmcnt(35)
    buffer_load_dwordx4 v5, s[8:11], s40 offen offset:1024  lds
    s_waitcnt vmcnt(35)
    buffer_load_dwordx4 v6, s[8:11], s40 offen offset:2048  lds
    s_waitcnt vmcnt(35)
    s_add_i32 s44, s38, -4
    v_mov_b32 v22, s44
    ds_write_b32 v19, v22
    buffer_load_dwordx4 v7, s[8:11], s40 offen offset:3072  lds
    s_add_u32 m0, m0, 4096
    s_waitcnt vmcnt(35)
    buffer_load_dwordx4 v4, s[8:11], s41 offen offset:0  lds
    s_waitcnt vmcnt(35)
    buffer_load_dwordx4 v5, s[8:11], s41 offen offset:1024  lds
    s_waitcnt vmcnt(35)
    buffer_load_dwordx4 v6, s[8:11], s41 offen offset:2048  lds
    s_waitcnt vmcnt(35)
    buffer_load_dwordx4 v7, s[8:11], s41 offen offset:3072  lds
    s_mov_b32 m0, s39
    s_waitcnt vmcnt(35)
    buffer_load_dwordx4 v4, s[12:15], s31 offen offset:0  lds
    s_waitcnt vmcnt(35)
    buffer_load_dwordx4 v5, s[12:15], s31 offen offset:1024  lds
    s_waitcnt vmcnt(35)
    buffer_load_dwordx4 v6, s[12:15], s31 offen offset:2048  lds
    s_waitcnt vmcnt(35)
    s_add_i32 s44, s38, -3
    v_mov_b32 v22, s44
    ds_write_b32 v19, v22
    buffer_load_dwordx4 v7, s[12:15], s31 offen offset:3072  lds
    s_add_u32 m0, m0, 4096
    s_waitcnt vmcnt(35)
    buffer_load_dwordx4 v4, s[12:15], s32 offen offset:0  lds
    s_waitcnt vmcnt(35)
    buffer_load_dwordx4 v5, s[12:15], s32 offen offset:1024  lds
    s_waitcnt vmcnt(35)
    buffer_load_dwordx4 v6, s[12:15], s32 offen offset:2048  lds
    s_waitcnt vmcnt(35)
    buffer_load_dwordx4 v7, s[12:15], s32 offen offset:3072  lds
    s_branch L_next
.p2align 8
    s_waitcnt vmcnt(36)
    buffer_load_dwordx4 v4, s[8:11], s40 offen offset:0  lds
    s_waitcnt vmcnt(36)
    buffer_load_dwordx4 v5, s[8:11], s40 offen offset:1024  lds
    s_waitcnt vmcnt(36)
    buffer_load_dwordx4 v6, s[8:11], s40 offen offset:2048  lds
    s_waitcnt vmcnt(36)
    buffer_load_dwordx4 v7, s[8:11], s40 offen offset:3072  lds
    s_add_u32 m0, m0, 4096
    s_waitcnt vmcnt(36)
    s_add_i32 s44, s38, -4
    v_mov_b32 v22, s44
    ds_write_b32 v19, v22
    buffer_load_dwordx4 v4, s[8:11], s41 offen offset:0  lds
    s_waitcnt vmcnt(36)
    buffer_load_dwordx4 v5, s[8:11], s41 offen offset:1024  lds
    s_waitcnt vmcnt(36)
    buffer_load_dwordx4 v6, s[8:11], s41 offen offset:2048  lds
    s_waitcnt vmcnt(36)
    buffer_load_dwordx4 v7, s[8:11], s41 offen offset:3072  lds
    s_mov_b32 m0, s39
    s_waitcnt vmcnt(36)
    buffer_load_dwordx4 v4, s[12:15], s31 offen offset:0  lds
    s_waitcnt vmcnt(36)
    buffer_load_dwordx4 v5, s[12:15], s31 offen offset:1024  lds
    s_waitcnt vmcnt(36)
    buffer_load_dwordx4 v6, s[12:15], s31 offen offset:2048  lds
    s_waitcnt vmcnt(36)
    buffer_load_dwordx4 v7, s[12:15], s31 offen offset:3072  lds
    s_add_u32 m0, m0, 4096
    s_waitcnt vmcnt(36)
    s_add_i32 s44, s38, -3
    v_mov_b32 v22, s44
    ds_write_b32 v19, v22
    buffer_load_dwordx4 v4, s[12:15], s32 offen offset:0  lds
    s_waitcnt vmcnt(36)
    buffer_load_dwordx4 v5, s[12:15], s32 offen offset:1024  lds
    s_waitcnt vmcnt(36)
    buffer_load_dwordx4 v6, s[12:15], s32 offen offset:2048  lds
    s_waitcnt vmcnt(36)
    buffer_load_dwordx4 v7, s[12:15], s32 offen offset:3072  lds
    s_branch L_next
.p2align 8
    s_waitcnt vmcnt(37)
    buffer_load_dwordx4 v4, s[8:11], s40 offen offset:0  lds
    s_waitcnt vmcnt(37)
    buffer_load_dwordx4 v5, s[8:11], s40 offen offset:1024  lds
    s_waitcnt vmcnt(37)
    buffer_load_dwordx4 v6, s[8:11], s40 offen offset:2048  lds
    s_waitcnt vmcnt(37)
    buffer_load_dwordx4 v7, s[8:11], s40 offen offset:3072  lds
    s_add_u32 m0, m0, 4096
    s_waitcnt vmcnt(37)
    buffer_load_dwordx4 v4, s[8:11], s41 offen offset:0  lds
    s_waitcnt vmcnt(37)
    s_add_i32 s44, s38, -4
    v_mov_b32 v22, s44
    ds_write_b32 v19, v22
    buffer_load_dwordx4 v5, s[8:11], s41 offen offset:1024  lds
    s_waitcnt vmcnt(37)
    buffer_load_dwordx4 v6, s[8:11], s41 offen offset:2048  lds
    s_waitcnt vmcnt(37)
    buffer_load_dwordx4 v7, s[8:11], s41 offen offset:3072  lds
    s_mov_b32 m0, s39
    s_waitcnt vmcnt(37)
    buffer_load_dwordx4 v4, s[12:15], s31 offen offset:0  lds
    s_waitcnt vmcnt(37)
    buffer_load_dwordx4 v5, s[12:15], s31 offen offset:1024  lds
    s_waitcnt vmcnt(37)
    buffer_load_dwordx4 v6, s[12:15], s31 offen offset:2048  lds
    s_waitcnt vmcnt(37)
    buffer_load_dwordx4 v7, s[12:15], s31 offen offset:3072  lds
    s_add_u32 m0, m0, 4096
    s_waitcnt vmcnt(37)
    buffer_load_dwordx4 v4, s[12:15], s32 offen offset:0  lds
    s_waitcnt vmcnt(37)
    s_add_i32 s44, s38, -3
    v_mov_b32 v22, s44
    ds_write_b32 v19, v22
    buffer_load_dwordx4 v5, s[12:15], s32 offen offset:1024  lds
    s_waitcnt vmcnt(37)
    buffer_load_dwordx4 v6, s[12:15], s32 offen offset:2048  lds
    s_waitcnt vmcnt(37)
    buffer_load_dwordx4 v7, s[12:15], s32 offen offset:3072  lds
    s_branch L_next
.p2align 8
    s_waitcnt vmcnt(38)
    buffer_load_dwordx4 v4, s[8:11], s40 offen offset:0  lds
    s_waitcnt vmcnt(38)
    buffer_load_dwordx4 v5, s[8:11], s40 offen offset:1024  lds
    s_waitcnt vmcnt(38)
    buffer_load_dwordx4 v6, s[8:11], s40 offen offset:2048  lds
    s_waitcnt vmcnt(38)
    buffer_load_dwordx4 v7, s[8:11], s40 offen offset:3072  lds
    s_add_u32 m0, m0, 4096
    s_waitcnt vmcnt(38)
    buffer_load_dwordx4 v4, s[8:11], s41 offen offset:0  lds
    s_waitcnt vmcnt(38)
    buffer_load_dwordx4 v5, s[8:11], s41 offen offset:1024  lds
    s_waitcnt vmcnt(38)
    s_add_i32 s44, s38, -4
    v_mov_b32 v22, s44
    ds_write_b32 v19, v22
    buffer_load_dwordx4 v6, s[8:11], s41 offen offset:2048  lds
    s_waitcnt vmcnt(38)
    buffer_load_dwordx4 v7, s[8:11], s41 offen offset:3072  lds
    s_mov_b32 m0, s39
    s_waitcnt vmcnt(38)
    buffer_load_dwordx4 v4, s[12:15], s31 offen offset:0  lds
    s_waitcnt vmcnt(38)
    buffer_load_dwordx4 v5, s[12:15], s31 offen offset:1024  lds
    s_waitcnt vmcnt(38)
    buffer_load_dwordx4 v6, s[12:15], s31 offen offset:2048  lds
    s_waitcnt vmcnt(38)
    buffer_load_dwordx4 v7, s[12:15], s31 offen offset:3072  lds
    s_add_u32 m0, m0, 4096
    s_waitcnt vmcnt(38)
    buffer_load_dwordx4 v4, s[12:15], s32 offen offset:0  lds
    s_waitcnt vmcnt(38)
    buffer_load_dwordx4 v5, s[12:15], s32 offen offset:1024  lds
    s_waitcnt vmcnt(38)
    s_add_i32 s44, s38, -3
    v_mov_b32 v22, s44
    ds_write_b32 v19, v22
    buffer_load_dwordx4 v6, s[12:15], s32 offen offset:2048  lds
    s_waitcnt vmcnt(38)
    buffer_load_dwordx4 v7, s[12:15], s32 offen offset:3072  lds
    s_branch L_next
.p2align 8
    s_waitcnt vmcnt(39)
    buffer_load_dwordx4 v4, s[8:11], s40 offen offset:0  lds
    s_waitcnt vmcnt(39)
    buffer_load_dwordx4 v5, s[8:11], s40 offen offset:1024  lds
    s_waitcnt vmcnt(39)
    buffer_load_dwordx4 v6, s[8:11], s40 offen offset:2048  lds
    s_waitcnt vmcnt(39)
    buffer_load_dwordx4 v7, s[8:11], s40 offen offset:3072  lds
    s_add_u32 m0, m0, 4096
    s_waitcnt vmcnt(39)
    buffer_load_dwordx4 v4, s[8:11], s41 offen offset:0  lds
    s_waitcnt vmcnt(39)
    buffer_load_dwordx4 v5, s[8:11], s41 offen offset:1024  lds
    s_waitcnt vmcnt(39)
    buffer_load_dwordx4 v6, s[8:11], s41 offen offset:2048  lds
    s_waitcnt vmcnt(39)
    s_add_i32 s44, s38, -4
    v_mov_b32 v22, s44
    ds_write_b32 v19, v22
    buffer_load_dwordx4 v7, s[8:11], s41 offen offset:3072  lds
    s_mov_b32 m0, s39
    s_waitcnt vmcnt(39)
    buffer_load_dwordx4 v4, s[12:15], s31 offen offset:0  lds
    s_waitcnt vmcnt(39)
    buffer_load_dwordx4 v5, s[12:15], s31 offen offset:1024  lds
    s_waitcnt vmcnt(39)
    buffer_load_dwordx4 v6, s[12:15], s31 offen offset:2048  lds
    s_waitcnt vmcnt(39)
    buffer_load_dwordx4 v7, s[12:15], s31 offen offset:3072  lds
    s_add_u32 m0, m0, 4096
    s_waitcnt vmcnt(39)
    buffer_load_dwordx4 v4, s[12:15], s32 offen offset:0  lds
    s_waitcnt vmcnt(39)
    buffer_load_dwordx4 v5, s[12:15], s32 offen offset:1024  lds
    s_waitcnt vmcnt(39)
    buffer_load_dwordx4 v6, s[12:15], s32 offen offset:2048  lds
    s_waitcnt vmcnt(39)
    s_add_i32 s44, s38, -3
    v_mov_b32 v22, s44
    ds_write_b32 v19, v22
    buffer_load_dwordx4 v7, s[12:15], s32 offen offset:3072  lds
    s_branch L_next
.p2align 8
L_code_end:
    s_endpgm
.section .rodata,"a"
.p2align 6
.amdhsa_kernel standalone__paged_block_table_kv_pagedattention__sampling_kernel
  .amdhsa_next_free_vgpr 176
  .amdhsa_next_free_sgpr 96
  .amdhsa_accum_offset 176
  .amdhsa_group_segment_fixed_size 0
  .amdhsa_kernarg_size 64
  .amdhsa_user_sgpr_count 2
  .amdhsa_user_sgpr_kernarg_segment_ptr 1
  .amdhsa_system_sgpr_workgroup_id_x 1
  .amdhsa_float_denorm_mode_32 3
.end_amdhsa_kernel
```
